```python
import torch

def _softmax(x, axis=-1):
    return torch.softmax(x, dim=axis)
def _gelu(x):
    return torch.nn.functional.gelu(x, approximate="tanh")
def _silu(x):
    return torch.nn.functional.silu(x)
def _sigmoid(x):
    return torch.sigmoid(x)
def _layernorm(x, axis=-1, eps=1e-5):
    m = x.mean(dim=axis, keepdim=True)
    v = x.var(dim=axis, keepdim=True, unbiased=False)
    return (x - m) / torch.sqrt(v + eps)
def _scatter_add(tgt, idx, src, axis=0):
    return tgt.clone().index_add_(axis, idx, src)
def _segment_sum(src, seg, n):
    out = torch.zeros((n,) + src.shape[1:], dtype=src.dtype)
    return out.index_add_(0, seg, src)
def _pad(x, pw):
    flat = tuple(v for pair in reversed(pw) for v in pair)
    return torch.nn.functional.pad(x, flat)

kernel_name = 'recurrent_scan__spectral_gfnet__swiglu_ffn__prompt'

def setup_inputs():

    _w = (lambda a: (lambda t: t.to(torch.bfloat16) if t.is_floating_point() else t)(torch.as_tensor(a)))
    def _A_setup():
        B, S, D = 1, 2048, 448
        Df = D // 2 + 1
        return {
            "x": _w((lambda *s: torch.randn(*s, dtype=torch.bfloat16) * 0.05)(B, S, D)),
            "w_r": _w((lambda *s: torch.randn(*s, dtype=torch.bfloat16) * 0.2)(S, Df) * 0.02),
            "w_i": _w((lambda *s: torch.randn(*s, dtype=torch.bfloat16) * 0.2)(S, Df) * 0.02),
        }
    _A_in = _A_setup()

    def _B_setup():
        B, S, D, F = 1, 2048, 448, 1792
        return {
            "x": _w((lambda *s: torch.randn(*s, dtype=torch.bfloat16) * 0.05)(B, S, D)),
            "w_gate": _w((lambda *s: torch.randn(*s, dtype=torch.bfloat16) * 0.2)(D, F)),
            "w_up": _w((lambda *s: torch.randn(*s, dtype=torch.bfloat16) * 0.2)(D, F)),
            "w_down": _w((lambda *s: torch.randn(*s, dtype=torch.bfloat16) * 0.2)(F, D)),
        }
    _B_in = _B_setup()

    return {
        "A_x": _A_in["x"],
        "A_w_r": _A_in["w_r"],
        "A_w_i": _A_in["w_i"],
        "B_x": _B_in["x"],
        "B_w_gate": _B_in["w_gate"],
        "B_w_up": _B_in["w_up"],
        "B_w_down": _B_in["w_down"],
    }

def reference(A_x, A_w_r, A_w_i, B_x, B_w_gate, B_w_up, B_w_down):
    def _A_ref(x, w_r, w_i):
        B, S, D = x.shape
        X = (lambda x, axes=(-2,-1): torch.fft.rfft2(x.float(), dim=axes))(x, axes=(-2, -1))
        W = w_r + 1j * w_i
        X = X * W
        y = (lambda x, s, axes=(-2,-1): torch.fft.irfft2(x, s=s, dim=axes).to(torch.bfloat16))(X, (S, D), axes=(-2, -1))
        return y

    def _B_ref(x, w_gate, w_up, w_down):
        g = _silu(x @ w_gate)
        u = x @ w_up
        return (g * u) @ w_down

    x = A_x
    xn = _layernorm(x, axis=-1)
    s = _A_ref(xn, A_w_r, A_w_i)
    g = _silu(_B_ref(xn, B_w_gate, B_w_up, B_w_down))
    return x + s * g
```

```asm
; @launch grid=(256,1,1) block=(512,1,1) lds=163840
.amdgcn_target "amdgcn-amd-amdhsa--gfx950"
.text
.globl recurrent_scan__spectral_gfnet__swiglu_ffn__prompt_kernel
.p2align 8
.type recurrent_scan__spectral_gfnet__swiglu_ffn__prompt_kernel,@function
recurrent_scan__spectral_gfnet__swiglu_ffn__prompt_kernel:
    s_cmp_ge_u32 s2, 0x100
    s_cbranch_scc1 KEND
    s_load_dwordx2 s[4:5], s[0:1], 0
    s_load_dwordx2 s[8:9], s[0:1], 32
    s_load_dwordx2 s[12:13], s[0:1], 40
    s_load_dwordx2 s[16:17], s[0:1], 72
    s_load_dwordx2 s[28:29], s[0:1], 64
    s_getpc_b64 s[100:101]
PCREF:
    v_lshrrev_b32 v2, 6, v0
    s_lshr_b32 s47, s2, 3
    v_lshl_add_u32 v255, s47, 3, v2
    v_readfirstlane_b32 s3, v2
    v_lshlrev_b32 v255, 7, v255
    v_and_b32 v1, 63, v0
    v_min_u32 v255, KEND-PCREF, v255
    v_lshlrev_b32 v2, 4, v1
    global_load_dword v255, v255, s[100:101]
    s_and_b32 s33, s2, 7
    s_mov_b32 s6, 1835008
    s_mov_b32 s7, 0x00020000
    s_mov_b32 s18, 0x10000000
    s_mov_b32 s19, 0x00020000
    s_mov_b32 s30, 256
    s_mov_b32 s31, 0x00020000
    s_cmp_ge_u32 s2, 32
    s_cbranch_scc1 FFN
    s_lshl_b32 s2, s33, 2
    s_add_u32 s2, s2, s47
    s_mul_i32 s35, s2, 896
    s_mul_i32 s49, s3, 229376
    s_add_u32 s35, s35, s49
    s_mul_i32 s36, s3, 7424
    s_mov_b32 m0, s36
    s_add_u32 s49, s36, 7424
    s_mov_b32 exec_hi, 0x00ffffff
    s_waitcnt lgkmcnt(0)
XL:
    buffer_load_dwordx4 v2, s[4:7], s35 offen lds
    s_add_u32 m0, m0, 928
    s_add_u32 s35, s35, 28672
    s_cmp_lt_u32 m0, s49
    s_cbranch_scc1 XL
    s_mov_b32 exec_hi, -1
    s_branch SPEC
FFN:
    s_mov_b32 s11, 0x00020000
    s_mov_b32 s15, 0x00020000
    s_load_dwordx2 s[20:21], s[0:1], 48
    s_load_dwordx2 s[24:25], s[0:1], 56
    s_sub_u32 s37, s47, 4
    v_lshrrev_b32 v3, 3, v1
    s_mul_i32 s34, s37, 37
    v_and_b32 v4, 7, v1
    s_lshr_b32 s34, s34, 8
    v_lshrrev_b32 v5, 4, v1
    s_lshl_b32 s3, s3, 2
    s_lshr_b32 s3, 0x76325410, s3
    s_and_b32 s3, s3, 7
    s_and_b32 s38, s3, 3
    v_and_b32 v8, 1, v5
    s_lshr_b32 s39, s3, 2
    s_and_b32 s62, s34, 2
    s_mul_i32 s63, s62, 7
    s_sub_u32 s37, s37, s63
    s_lshl_b32 s60, s37, 1
    s_and_b32 s89, s33, 6
    s_add_u32 s89, s89, s37
    s_mul_i32 s63, s62, 0
    s_add_u32 s89, s89, s63
    s_and_b32 s61, s33, 1
    s_mul_i32 s63, s61, 14
    s_add_u32 s37, s37, s63
    s_and_b32 s63, s34, 1
    s_lshl_b32 s63, s63, 1
    s_and_b32 s49, s3, 1
    s_lshl_b32 s49, s49, 1
    v_or_b32 v8, s49, v8
    s_mul_i32 s90, s89, 37
    v_lshlrev_b32 v8, 1, v8
    s_lshr_b32 s90, s90, 8
    v_xor_b32 v8, v8, v4
    s_mul_i32 s90, s90, 7
    v_lshlrev_b32 v8, 4, v8
    s_sub_u32 s89, s89, s90
    v_mul_u32_u24 v9, 3584, v3
    s_lshl_b32 s89, s89, 7
    v_add_u32 v8, v8, v9
    s_mul_i32 s45, s3, 28672
    v_xor_b32 v7, v4, v5
    s_lshl_b32 s49, s37, 7
    v_lshlrev_b32 v7, 4, v7
    s_add_u32 s45, s45, s49
    v_mul_u32_u24 v6, 28672, v3
    s_lshl_b32 s46, s3, 11
    v_add_u32 v6, v6, v7
    s_mov_b32 s10, 1605632
    v_xor_b32 v7, 64, v6
    s_mov_b32 s14, 1605632
    s_lshr_b32 s48, s38, 1
    s_xor_b32 s48, s48, s33
    s_lshl_b32 s48, s48, 2
    s_add_u32 s48, s48, s62
    s_and_b32 s49, s38, 1
    s_add_u32 s48, s48, s49
    s_mul_i32 s40, s48, 896
    s_mul_i32 s49, s39, 917504
    s_add_u32 s40, s40, s49
    s_lshl_b32 s44, s38, 13
    s_lshl_b32 s49, s39, 12
    s_add_u32 s44, s44, s49
    s_add_u32 s90, s89, 128
    s_cmp_eq_u32 s90, 896
    s_cselect_b32 s90, 0, s90
    s_and_b32 s54, s63, 1
    s_lshl_b32 s54, s54, 6
    v_xor_b32 v11, s54, v6
    v_xor_b32 v13, s54, v7
    s_add_u32 s65, s89, s40
    s_mul_i32 s49, s89, 1792
    s_add_u32 m0, s46, 114688
    s_add_u32 s49, s49, s45
    s_waitcnt lgkmcnt(0)
    buffer_load_dwordx4 v8, s[8:11], s49 offen lds
    s_add_u32 m0, s46, 115712
    s_nop 0
    s_nop 0
    buffer_load_dwordx4 v8, s[12:15], s49 offen lds
    s_xor_b32 s54, s63, 0
    s_lshl_b32 s64, s54, 10
    s_mul_i32 s54, s54, 229376
    s_add_u32 s64, s64, s44
    s_add_u32 s54, s54, s65
    s_add_u32 m0, s64, 16384
    s_nop 0
    s_nop 0
    buffer_load_dwordx4 v11, s[4:7], s54 offen lds
    s_xor_b32 s54, s63, 1
    s_lshl_b32 s64, s54, 10
    s_mul_i32 s54, s54, 229376
    s_add_u32 s64, s64, s44
    s_add_u32 s54, s54, s65
    s_add_u32 m0, s64, 16384
    s_nop 0
    s_nop 0
    buffer_load_dwordx4 v13, s[4:7], s54 offen lds
    s_add_u32 s41, s40, 228352
    s_add_u32 s42, s40, 456704
    s_add_u32 s43, s40, 685056
    s_add_u32 s91, s90, 128
    s_cmp_eq_u32 s91, 896
    s_cselect_b32 s91, 0, s91
    s_add_u32 s92, s91, 128
    s_cmp_eq_u32 s92, 896
    s_cselect_b32 s92, 0, s92
    s_add_u32 s93, s92, 128
    s_cmp_eq_u32 s93, 896
    s_cselect_b32 s93, 0, s93
    v_lshlrev_b32 v9, 1, v5
    v_xor_b32 v9, v9, v4
    v_lshlrev_b32 v9, 4, v9
    v_mul_u32_u24 v3, 896, v3
    v_add_u32 v9, v9, v3
    v_and_b32 v3, 15, v1
    v_bfe_u32 v4, v1, 1, 3
    v_xor_b32 v4, v4, v5
    s_and_b32 s49, s38, 2
    s_lshl_b32 s49, s49, 1
    v_xor_b32 v4, s49, v4
    v_lshlrev_b32 v4, 4, v4
    v_lshl_add_u32 v4, v3, 7, v4
    s_lshl_b32 s49, s38, 13
    s_add_u32 s49, s49, 16384
    v_add_u32 v10, s49, v4
    v_xor_b32 v12, 64, v10
    v_bfe_u32 v3, v1, 3, 2
    s_lshl_b32 s49, s39, 1
    s_and_b32 s54, s38, 1
    s_or_b32 s58, s49, s54
    v_xor_b32 v3, s58, v3
    v_lshlrev_b32 v3, 5, v3
    v_bfe_u32 v4, v1, 2, 2
    v_lshl_add_u32 v3, v4, 7, v3
    v_and_b32 v4, 3, v1
    v_lshl_add_u32 v3, v4, 3, v3
    v_lshl_add_u32 v3, v5, 11, v3
    s_and_b32 s49, s38, 2
    s_lshl_b32 s49, s49, 12
    s_add_u32 s49, s49, 114688
    v_add_u32 v14, s49, v3
    v_xor_b32 v15, 32, v14
    v_xor_b32 v16, 0x2000, v14
    v_xor_b32 v17, 0x2000, v15
    v_mov_b32 v158, 0x3f803f80
    v_mov_b32 v159, 0x3f803f80
    v_mov_b32 v160, 0x3f803f80
    v_mov_b32 v161, 0x3f803f80
    v_min_u32 v251, 6, v1
    v_lshlrev_b32 v251, 7, v251
    s_lshl_b32 s49, s2, 3
    s_add_u32 s49, s49, s3
    s_sub_u32 s49, s49, 256
    s_mul_i32 s55, s49, 896
    s_mov_b32 s22, 1605632
    s_mov_b32 s23, 0x00020000
    s_mul_i32 s35, s34, 5
    s_lshr_b32 s54, s89, 7
    s_add_u32 s35, s35, s54
    s_mul_i32 s54, s35, 37
    s_lshr_b32 s54, s54, 8
    s_mul_i32 s54, s54, 7
    s_sub_u32 s35, s35, s54
    s_lshl_b32 s50, s33, 2
    s_add_u32 s50, s50, s34
    s_mul_i32 s51, s38, 200704
    s_mul_i32 s54, s61, 802816
    s_add_u32 s51, s51, s54
    s_mul_i32 s54, s39, 14336
    s_add_u32 s51, s51, s54
    s_lshl_b32 s54, s35, 7
    s_add_u32 s51, s51, s54
    s_add_u32 s52, s51, 6144
    s_xor_b32 s54, s39, s50
    s_and_b32 s54, s54, 1
    s_lshl_b32 s54, s54, 11
    s_lshl_b32 s53, s38, 12
    s_add_u32 s53, s53, s54
    s_barrier
    s_xor_b32 s54, s63, 2
    s_lshl_b32 s64, s54, 10
    s_mul_i32 s54, s54, 229376
    s_add_u32 s64, s64, s44
    s_add_u32 s54, s54, s65
    s_add_u32 m0, s64, 16384
    s_nop 0
    s_nop 0
    buffer_load_dwordx4 v11, s[4:7], s54 offen lds
    s_xor_b32 s54, s63, 3
    s_lshl_b32 s64, s54, 10
    s_mul_i32 s54, s54, 229376
    s_add_u32 s64, s64, s44
    s_add_u32 s54, s54, s65
    s_add_u32 m0, s64, 16384
    s_nop 0
    s_nop 0
    buffer_load_dwordx4 v13, s[4:7], s54 offen lds
    s_mul_i32 s49, s90, 1792
    s_add_u32 m0, s46, 131072
    s_add_u32 s49, s49, s45
    buffer_load_dwordx4 v8, s[8:11], s49 offen lds
    s_mul_i32 s49, s90, 1792
    s_add_u32 m0, s46, 132096
    s_add_u32 s49, s49, s45
    buffer_load_dwordx4 v8, s[12:15], s49 offen lds
    s_add_u32 m0, s44, 49152
    s_add_u32 s49, s40, s90
    buffer_load_dwordx4 v6, s[4:7], s49 offen offset:0 lds
    s_add_u32 m0, s44, 49152
    s_add_u32 s49, s41, s90
    buffer_load_dwordx4 v7, s[4:7], s49 offen offset:1024 lds
    s_add_u32 m0, s44, 49152
    s_add_u32 s49, s42, s90
    buffer_load_dwordx4 v6, s[4:7], s49 offen offset:2048 lds
    s_add_u32 m0, s44, 49152
    s_add_u32 s49, s43, s90
    buffer_load_dwordx4 v7, s[4:7], s49 offen offset:3072 lds
    s_mov_b64 exec, 0
    s_cmp_eq_u32 s3, 0
    s_cbranch_scc1 PADF0
    s_cmp_eq_u32 s3, 1
    s_cbranch_scc1 PADF12
    s_cmp_eq_u32 s3, 2
    s_cbranch_scc1 PADF24
    s_cmp_eq_u32 s3, 3
    s_cbranch_scc1 PADF36
    s_cmp_eq_u32 s3, 4
    s_cbranch_scc1 PADF48
    s_cmp_eq_u32 s3, 5
    s_cbranch_scc1 PADF60
    s_cmp_eq_u32 s3, 6
    s_cbranch_scc1 PADF72
    s_cmp_eq_u32 s3, 7
    s_cbranch_scc1 PADF84
RETF:
    s_mov_b64 exec, -1
    s_waitcnt vmcnt(6)
    s_barrier
    ds_read_b128 v[118:121], v10 offset:0
    ds_read_b64_tr_b16 v[86:87], v14 offset:0
    ds_read_b64_tr_b16 v[88:89], v14 offset:512
    ds_read_b64_tr_b16 v[94:95], v14 offset:1024
    ds_read_b64_tr_b16 v[96:97], v14 offset:1536
    ds_read_b128 v[122:125], v10 offset:2048
    ds_read_b64_tr_b16 v[90:91], v15 offset:0
    ds_read_b64_tr_b16 v[92:93], v15 offset:512
    ds_read_b64_tr_b16 v[98:99], v15 offset:1024
    ds_read_b64_tr_b16 v[100:101], v15 offset:1536
    ds_read_b128 v[126:129], v10 offset:4096
    ds_read_b128 v[130:133], v10 offset:6144
    s_waitcnt lgkmcnt(9)
    v_mfma_f32_16x16x32_bf16 v[22:25], v[86:89], v[118:121], 0
    ds_read_b128 v[134:137], v12 offset:0
    buffer_load_dword v250, v251, s[20:23], s55 offen
    s_waitcnt lgkmcnt(8)
    v_mfma_f32_16x16x32_bf16 v[54:57], v[94:97], v[118:121], 0
    ds_read_b64_tr_b16 v[102:103], v16 offset:0
    v_mfma_f32_16x16x32_bf16 v[150:153], v[86:89], v[158:161], 0
    ds_read_b64_tr_b16 v[104:105], v16 offset:512
    v_mfma_f32_16x16x32_bf16 v[154:157], v[94:97], v[158:161], 0
    ds_read_b64_tr_b16 v[110:111], v16 offset:1024
    s_waitcnt lgkmcnt(8)
    v_mfma_f32_16x16x32_bf16 v[38:41], v[90:93], v[118:121], 0
    s_mul_i32 s49, s91, 1792
    s_add_u32 m0, s46, 147456
    s_add_u32 s49, s49, s45
    buffer_load_dwordx4 v8, s[8:11], s49 offen lds
    s_waitcnt lgkmcnt(6)
    v_mfma_f32_16x16x32_bf16 v[70:73], v[98:101], v[118:121], 0
    ds_read_b64_tr_b16 v[112:113], v16 offset:1536
    v_mfma_f32_16x16x32_bf16 v[26:29], v[86:89], v[122:125], 0
    ds_read_b128 v[138:141], v12 offset:2048
    v_mfma_f32_16x16x32_bf16 v[58:61], v[94:97], v[122:125], 0
    s_mul_i32 s49, s91, 1792
    s_add_u32 m0, s46, 148480
    s_add_u32 s49, s49, s45
    buffer_load_dwordx4 v8, s[12:15], s49 offen lds
    v_mfma_f32_16x16x32_bf16 v[42:45], v[90:93], v[122:125], 0
    ds_read_b64_tr_b16 v[106:107], v17 offset:0
    v_mfma_f32_16x16x32_bf16 v[74:77], v[98:101], v[122:125], 0
    ds_read_b64_tr_b16 v[108:109], v17 offset:512
    s_waitcnt lgkmcnt(9)
    v_mfma_f32_16x16x32_bf16 v[30:33], v[86:89], v[126:129], 0
    s_add_u32 m0, s44, 81920
    s_add_u32 s49, s40, s91
    buffer_load_dwordx4 v6, s[4:7], s49 offen offset:0 lds
    v_mfma_f32_16x16x32_bf16 v[62:65], v[94:97], v[126:129], 0
    ds_read_b64_tr_b16 v[114:115], v17 offset:1024
    v_mfma_f32_16x16x32_bf16 v[46:49], v[90:93], v[126:129], 0
    ds_read_b64_tr_b16 v[116:117], v17 offset:1536
    v_mfma_f32_16x16x32_bf16 v[78:81], v[98:101], v[126:129], 0
    ds_read_b128 v[142:145], v12 offset:4096
    s_waitcnt lgkmcnt(11)
    v_mfma_f32_16x16x32_bf16 v[34:37], v[86:89], v[130:133], 0
    s_add_u32 m0, s44, 81920
    s_add_u32 s49, s41, s91
    buffer_load_dwordx4 v7, s[4:7], s49 offen offset:1024 lds
    v_mfma_f32_16x16x32_bf16 v[66:69], v[94:97], v[130:133], 0
    ds_read_b128 v[146:149], v12 offset:6144
    v_mfma_f32_16x16x32_bf16 v[50:53], v[90:93], v[130:133], 0
    v_add_u32 v11, 0x10000, v10
    v_mfma_f32_16x16x32_bf16 v[82:85], v[98:101], v[130:133], 0
    v_add_u32 v13, 0x10000, v12
    s_waitcnt lgkmcnt(9)
    v_mfma_f32_16x16x32_bf16 v[22:25], v[102:105], v[134:137], v[22:25]
    s_waitcnt vmcnt(5)
    s_waitcnt lgkmcnt(0)
    s_barrier
    ds_read_b128 v[118:121], v10 offset:32768
    v_mfma_f32_16x16x32_bf16 v[54:57], v[110:113], v[134:137], v[54:57]
    ds_read_b64_tr_b16 v[86:87], v14 offset:16384
    v_mfma_f32_16x16x32_bf16 v[38:41], v[106:109], v[134:137], v[38:41]
    s_add_u32 m0, s44, 81920
    s_add_u32 s49, s42, s91
    buffer_load_dwordx4 v6, s[4:7], s49 offen offset:2048 lds
    v_mfma_f32_16x16x32_bf16 v[70:73], v[114:117], v[134:137], v[70:73]
    ds_read_b64_tr_b16 v[88:89], v14 offset:16896
    v_mfma_f32_16x16x32_bf16 v[26:29], v[102:105], v[138:141], v[26:29]
    ds_read_b64_tr_b16 v[94:95], v14 offset:17408
    v_mfma_f32_16x16x32_bf16 v[58:61], v[110:113], v[138:141], v[58:61]
    ds_read_b64_tr_b16 v[96:97], v14 offset:17920
    v_mfma_f32_16x16x32_bf16 v[42:45], v[106:109], v[138:141], v[42:45]
    s_add_u32 m0, s44, 81920
    s_add_u32 s49, s43, s91
    buffer_load_dwordx4 v7, s[4:7], s49 offen offset:3072 lds
    v_mfma_f32_16x16x32_bf16 v[74:77], v[114:117], v[138:141], v[74:77]
    ds_read_b128 v[122:125], v10 offset:34816
    v_mfma_f32_16x16x32_bf16 v[30:33], v[102:105], v[142:145], v[30:33]
    ds_read_b64_tr_b16 v[90:91], v15 offset:16384
    v_mfma_f32_16x16x32_bf16 v[62:65], v[110:113], v[142:145], v[62:65]
    ds_read_b64_tr_b16 v[92:93], v15 offset:16896
    v_mfma_f32_16x16x32_bf16 v[46:49], v[106:109], v[142:145], v[46:49]
    s_mul_i32 s49, s92, 1792
    s_add_u32 m0, s46, 114688
    s_add_u32 s49, s49, s45
    buffer_load_dwordx4 v8, s[8:11], s49 offen lds
    v_mfma_f32_16x16x32_bf16 v[78:81], v[114:117], v[142:145], v[78:81]
    ds_read_b64_tr_b16 v[98:99], v15 offset:17408
    v_mfma_f32_16x16x32_bf16 v[34:37], v[102:105], v[146:149], v[34:37]
    ds_read_b64_tr_b16 v[100:101], v15 offset:17920
    v_mfma_f32_16x16x32_bf16 v[66:69], v[110:113], v[146:149], v[66:69]
    ds_read_b128 v[126:129], v10 offset:36864
    v_mfma_f32_16x16x32_bf16 v[50:53], v[106:109], v[146:149], v[50:53]
    s_mul_i32 s49, s92, 1792
    s_add_u32 m0, s46, 115712
    s_add_u32 s49, s49, s45
    buffer_load_dwordx4 v8, s[12:15], s49 offen lds
    v_mfma_f32_16x16x32_bf16 v[82:85], v[114:117], v[146:149], v[82:85]
    ds_read_b128 v[130:133], v10 offset:38912
    s_waitcnt lgkmcnt(9)
    v_mfma_f32_16x16x32_bf16 v[22:25], v[86:89], v[118:121], v[22:25]
    ds_read_b128 v[134:137], v12 offset:32768
    ds_read_b64_tr_b16 v[102:103], v16 offset:16384
    s_waitcnt lgkmcnt(9)
    v_mfma_f32_16x16x32_bf16 v[54:57], v[94:97], v[118:121], v[54:57]
    s_add_u32 m0, s44, 16384
    s_add_u32 s49, s40, s92
    buffer_load_dwordx4 v6, s[4:7], s49 offen offset:0 lds
    ds_read_b64_tr_b16 v[104:105], v16 offset:16896
    v_mfma_f32_16x16x32_bf16 v[150:153], v[86:89], v[158:161], v[150:153]
    ds_read_b64_tr_b16 v[110:111], v16 offset:17408
    v_mfma_f32_16x16x32_bf16 v[154:157], v[94:97], v[158:161], v[154:157]
    ds_read_b64_tr_b16 v[112:113], v16 offset:17920
    s_add_u32 m0, s44, 16384
    s_add_u32 s49, s41, s92
    buffer_load_dwordx4 v7, s[4:7], s49 offen offset:1024 lds
    s_waitcnt lgkmcnt(9)
    v_mfma_f32_16x16x32_bf16 v[38:41], v[90:93], v[118:121], v[38:41]
    ds_read_b128 v[138:141], v12 offset:34816
    ds_read_b64_tr_b16 v[106:107], v17 offset:16384
    s_waitcnt lgkmcnt(9)
    v_mfma_f32_16x16x32_bf16 v[70:73], v[98:101], v[118:121], v[70:73]
    ds_read_b64_tr_b16 v[108:109], v17 offset:16896
    v_mfma_f32_16x16x32_bf16 v[26:29], v[86:89], v[122:125], v[26:29]
    s_add_u32 m0, s44, 16384
    s_add_u32 s49, s42, s92
    buffer_load_dwordx4 v6, s[4:7], s49 offen offset:2048 lds
    ds_read_b64_tr_b16 v[114:115], v17 offset:17408
    v_mfma_f32_16x16x32_bf16 v[58:61], v[94:97], v[122:125], v[58:61]
    ds_read_b64_tr_b16 v[116:117], v17 offset:17920
    ds_read_b128 v[142:145], v12 offset:36864
    v_mfma_f32_16x16x32_bf16 v[42:45], v[90:93], v[122:125], v[42:45]
    s_add_u32 m0, s44, 16384
    s_add_u32 s49, s43, s92
    buffer_load_dwordx4 v7, s[4:7], s49 offen offset:3072 lds
    v_mfma_f32_16x16x32_bf16 v[74:77], v[98:101], v[122:125], v[74:77]
    ds_read_b128 v[146:149], v12 offset:38912
    s_add_u32 s94, s93, 128
    s_cmp_eq_u32 s94, 896
    s_cselect_b32 s94, 0, s94
    s_waitcnt lgkmcnt(13)
    v_mfma_f32_16x16x32_bf16 v[30:33], v[86:89], v[126:129], v[30:33]
    s_add_u32 s95, s94, 128
    s_cmp_eq_u32 s95, 896
    s_cselect_b32 s95, 0, s95
    v_bfe_u32 v3, v1, 3, 2
    v_mfma_f32_16x16x32_bf16 v[62:65], v[94:97], v[126:129], v[62:65]
    s_and_b32 s54, s38, 2
    v_mfma_f32_16x16x32_bf16 v[46:49], v[90:93], v[126:129], v[46:49]
    v_xor_b32 v3, s54, v3
    v_lshlrev_b32 v3, 5, v3
    v_mfma_f32_16x16x32_bf16 v[78:81], v[98:101], v[126:129], v[78:81]
    v_lshl_add_u32 v3, v4, 3, v3
    v_lshrrev_b32 v4, 2, v1
    s_waitcnt lgkmcnt(12)
    v_mfma_f32_16x16x32_bf16 v[34:37], v[86:89], v[130:133], v[34:37]
    v_lshl_add_u32 v3, v4, 7, v3
    v_mfma_f32_16x16x32_bf16 v[66:69], v[94:97], v[130:133], v[66:69]
    s_lshl_b32 s54, s38, 12
    v_add_u32 v18, s54, v3
    v_mfma_f32_16x16x32_bf16 v[50:53], v[90:93], v[130:133], v[50:53]
    v_xor_b32 v19, 32, v18
    v_xor_b32 v20, 64, v18
    v_mfma_f32_16x16x32_bf16 v[82:85], v[98:101], v[130:133], v[82:85]
    v_xor_b32 v21, 96, v18
    s_waitcnt lgkmcnt(9)
    v_mfma_f32_16x16x32_bf16 v[22:25], v[102:105], v[134:137], v[22:25]
    s_waitcnt vmcnt(6)
    s_waitcnt lgkmcnt(0)
    s_barrier
    ds_read_b128 v[118:121], v11 offset:0
    v_mfma_f32_16x16x32_bf16 v[54:57], v[110:113], v[134:137], v[54:57]
    ds_read_b64_tr_b16 v[86:87], v14 offset:32768
    s_mul_i32 s49, s89, 224
    s_add_u32 m0, s53, 0
    s_add_u32 s49, s49, s51
    buffer_load_dwordx4 v9, s[20:23], s49 offen offset:0 lds
    v_mfma_f32_16x16x32_bf16 v[38:41], v[106:109], v[134:137], v[38:41]
    ds_read_b64_tr_b16 v[88:89], v14 offset:33280
    ds_read_b64_tr_b16 v[94:95], v14 offset:33792
    v_mfma_f32_16x16x32_bf16 v[70:73], v[114:117], v[134:137], v[70:73]
    ds_read_b64_tr_b16 v[96:97], v14 offset:34304
    s_mul_i32 s49, s89, 224
    s_add_u32 m0, s53, 0
    s_add_u32 s49, s49, s52
    buffer_load_dwordx4 v9, s[20:23], s49 offen offset:1024 lds
    v_mfma_f32_16x16x32_bf16 v[26:29], v[102:105], v[138:141], v[26:29]
    ds_read_b128 v[122:125], v11 offset:2048
    ds_read_b64_tr_b16 v[90:91], v15 offset:32768
    v_mfma_f32_16x16x32_bf16 v[58:61], v[110:113], v[138:141], v[58:61]
    ds_read_b64_tr_b16 v[92:93], v15 offset:33280
    s_mul_i32 s49, s93, 1792
    s_add_u32 m0, s46, 131072
    s_add_u32 s49, s49, s45
    buffer_load_dwordx4 v8, s[8:11], s49 offen lds
    v_mfma_f32_16x16x32_bf16 v[42:45], v[106:109], v[138:141], v[42:45]
    ds_read_b64_tr_b16 v[98:99], v15 offset:33792
    ds_read_b64_tr_b16 v[100:101], v15 offset:34304
    v_mfma_f32_16x16x32_bf16 v[74:77], v[114:117], v[138:141], v[74:77]
    ds_read_b128 v[126:129], v11 offset:4096
    s_mul_i32 s49, s93, 1792
    s_add_u32 m0, s46, 132096
    s_add_u32 s49, s49, s45
    buffer_load_dwordx4 v8, s[12:15], s49 offen lds
    v_mfma_f32_16x16x32_bf16 v[30:33], v[102:105], v[142:145], v[30:33]
    ds_read_b128 v[130:133], v11 offset:6144
    v_and_b32 v247, 31, v1
    v_mfma_f32_16x16x32_bf16 v[62:65], v[110:113], v[142:145], v[62:65]
    v_lshlrev_b32 v247, 3, v247
    v_and_b32 v249, 15, v1
    v_mfma_f32_16x16x32_bf16 v[46:49], v[106:109], v[142:145], v[46:49]
    v_lshlrev_b32 v249, 4, v249
    s_lshl_b32 s56, s48, 8
    v_mfma_f32_16x16x32_bf16 v[78:81], v[114:117], v[142:145], v[78:81]
    s_add_u32 s56, s56, 12582912
    s_mul_i32 s57, s48, 56
    v_mfma_f32_16x16x32_bf16 v[34:37], v[102:105], v[146:149], v[34:37]
    s_lshl_b32 s54, s37, 1
    s_add_u32 s57, s57, s54
    v_mfma_f32_16x16x32_bf16 v[66:69], v[110:113], v[146:149], v[66:69]
    s_add_u32 s57, s57, s39
    s_lshl_b32 s57, s57, 12
    v_mfma_f32_16x16x32_bf16 v[50:53], v[106:109], v[146:149], v[50:53]
    s_lshl_b32 s65, s61, 1
    s_sub_u32 s65, 1, s65
    v_mfma_f32_16x16x32_bf16 v[82:85], v[114:117], v[146:149], v[82:85]
    s_mov_b32 s26, 1835008
    s_mov_b32 s27, 0x00020000
    s_waitcnt lgkmcnt(9)
    v_mfma_f32_16x16x32_bf16 v[22:25], v[86:89], v[118:121], v[22:25]
    ds_read_b128 v[134:137], v13 offset:0
    ds_read_b64_tr_b16 v[102:103], v16 offset:32768
    s_add_u32 m0, s44, 49152
    s_add_u32 s49, s40, s93
    buffer_load_dwordx4 v6, s[4:7], s49 offen offset:0 lds
    s_waitcnt lgkmcnt(9)
    v_mfma_f32_16x16x32_bf16 v[54:57], v[94:97], v[118:121], v[54:57]
    ds_read_b64_tr_b16 v[104:105], v16 offset:33280
    ds_read_b64_tr_b16 v[110:111], v16 offset:33792
    v_mfma_f32_16x16x32_bf16 v[150:153], v[86:89], v[158:161], v[150:153]
    ds_read_b64_tr_b16 v[112:113], v16 offset:34304
    s_add_u32 m0, s44, 49152
    s_add_u32 s49, s41, s93
    buffer_load_dwordx4 v7, s[4:7], s49 offen offset:1024 lds
    v_mfma_f32_16x16x32_bf16 v[154:157], v[94:97], v[158:161], v[154:157]
    ds_read_b128 v[138:141], v13 offset:2048
    ds_read_b64_tr_b16 v[106:107], v17 offset:32768
    s_waitcnt lgkmcnt(11)
    v_mfma_f32_16x16x32_bf16 v[38:41], v[90:93], v[118:121], v[38:41]
    ds_read_b64_tr_b16 v[108:109], v17 offset:33280
    s_add_u32 m0, s44, 49152
    s_add_u32 s49, s42, s93
    buffer_load_dwordx4 v6, s[4:7], s49 offen offset:2048 lds
    s_waitcnt lgkmcnt(10)
    v_mfma_f32_16x16x32_bf16 v[70:73], v[98:101], v[118:121], v[70:73]
    ds_read_b64_tr_b16 v[114:115], v17 offset:33792
    ds_read_b64_tr_b16 v[116:117], v17 offset:34304
    v_mfma_f32_16x16x32_bf16 v[26:29], v[86:89], v[122:125], v[26:29]
    ds_read_b128 v[142:145], v13 offset:4096
    s_add_u32 m0, s44, 49152
    s_add_u32 s49, s43, s93
    buffer_load_dwordx4 v7, s[4:7], s49 offen offset:3072 lds
    v_mfma_f32_16x16x32_bf16 v[58:61], v[94:97], v[122:125], v[58:61]
    ds_read_b128 v[146:149], v13 offset:6144
    s_mul_i32 s59, s50, 56
    v_mfma_f32_16x16x32_bf16 v[42:45], v[90:93], v[122:125], v[42:45]
    s_mul_i32 s54, s38, 7
    s_add_u32 s59, s59, s54
    v_mfma_f32_16x16x32_bf16 v[74:77], v[98:101], v[122:125], v[74:77]
    s_mul_i32 s54, s61, 28
    s_add_u32 s59, s59, s54
    s_lshl_b32 s59, s59, 12
    s_waitcnt lgkmcnt(13)
    v_mfma_f32_16x16x32_bf16 v[30:33], v[86:89], v[126:129], v[30:33]
    s_lshl_b32 s54, s39, 11
    s_add_u32 s59, s59, s54
    v_mfma_f32_16x16x32_bf16 v[62:65], v[94:97], v[126:129], v[62:65]
    s_add_u32 s60, s60, s39
    s_mul_i32 s54, s60, 37
    v_mfma_f32_16x16x32_bf16 v[46:49], v[90:93], v[126:129], v[46:49]
    s_lshr_b32 s54, s54, 8
    s_add_u32 s54, s54, 1
    v_mfma_f32_16x16x32_bf16 v[78:81], v[98:101], v[126:129], v[78:81]
    s_lshl_b32 s54, s54, 4
    s_and_b32 s61, s38, 2
    s_waitcnt lgkmcnt(12)
    v_mfma_f32_16x16x32_bf16 v[34:37], v[86:89], v[130:133], v[34:37]
    s_mul_i32 s54, s54, s61
    s_add_u32 s60, s60, s54
    v_mfma_f32_16x16x32_bf16 v[66:69], v[94:97], v[130:133], v[66:69]
    s_lshl_b32 s54, s48, 8
    s_add_u32 s60, s60, s54
    v_mfma_f32_16x16x32_bf16 v[50:53], v[90:93], v[130:133], v[50:53]
    s_lshl_b32 s60, s60, 2
    s_add_u32 s60, s60, 12976128
    v_mfma_f32_16x16x32_bf16 v[82:85], v[98:101], v[130:133], v[82:85]
    s_lshl_b32 s61, s50, 10
    s_add_u32 s61, s61, 12976128
    s_waitcnt lgkmcnt(9)
    v_mfma_f32_16x16x32_bf16 v[22:25], v[102:105], v[134:137], v[22:25]
    s_waitcnt vmcnt(8)
    s_waitcnt vmcnt(6)
    s_waitcnt lgkmcnt(0)
    s_barrier
    ds_read_b128 v[118:121], v10 offset:0
    v_mfma_f32_16x16x32_bf16 v[54:57], v[110:113], v[134:137], v[54:57]
    ds_read_b64_tr_b16 v[86:87], v14 offset:0
    s_mul_i32 s49, s94, 1792
    s_add_u32 m0, s46, 147456
    s_add_u32 s49, s49, s45
    buffer_load_dwordx4 v8, s[8:11], s49 offen lds
    v_mfma_f32_16x16x32_bf16 v[38:41], v[106:109], v[134:137], v[38:41]
    ds_read_b64_tr_b16 v[88:89], v14 offset:512
    ds_read_b64_tr_b16 v[94:95], v14 offset:1024
    v_mfma_f32_16x16x32_bf16 v[70:73], v[114:117], v[134:137], v[70:73]
    ds_read_b64_tr_b16 v[96:97], v14 offset:1536
    ds_read_b128 v[122:125], v10 offset:2048
    v_mfma_f32_16x16x32_bf16 v[26:29], v[102:105], v[138:141], v[26:29]
    s_mul_i32 s49, s94, 1792
    s_add_u32 m0, s46, 148480
    s_add_u32 s49, s49, s45
    buffer_load_dwordx4 v8, s[12:15], s49 offen lds
    ds_read_b64_tr_b16 v[90:91], v15 offset:0
    v_mfma_f32_16x16x32_bf16 v[58:61], v[110:113], v[138:141], v[58:61]
    ds_read_b64_tr_b16 v[92:93], v15 offset:512
    ds_read_b64_tr_b16 v[98:99], v15 offset:1024
    v_mfma_f32_16x16x32_bf16 v[42:45], v[106:109], v[138:141], v[42:45]
    ds_read_b64_tr_b16 v[100:101], v15 offset:1536
    s_add_u32 m0, s44, 81920
    s_add_u32 s49, s40, s94
    buffer_load_dwordx4 v6, s[4:7], s49 offen offset:0 lds
    v_mfma_f32_16x16x32_bf16 v[74:77], v[114:117], v[138:141], v[74:77]
    ds_read_b128 v[126:129], v10 offset:4096
    v_mfma_f32_16x16x32_bf16 v[30:33], v[102:105], v[142:145], v[30:33]
    ds_read_b128 v[130:133], v10 offset:6144
    s_mul_i32 s36, s38, 7
    v_mfma_f32_16x16x32_bf16 v[62:65], v[110:113], v[142:145], v[62:65]
    s_lshl_b32 s36, 0x7f, s36
    s_lshl_b32 s62, s3, 15
    v_mfma_f32_16x16x32_bf16 v[46:49], v[106:109], v[142:145], v[46:49]
    s_lshl_b32 s54, s33, 10
    s_add_u32 s62, s62, s54
    v_mfma_f32_16x16x32_bf16 v[78:81], v[114:117], v[142:145], v[78:81]
    s_add_u32 s62, s62, 12649348
    s_lshl_b32 s63, s58, 9
    v_mfma_f32_16x16x32_bf16 v[34:37], v[102:105], v[146:149], v[34:37]
    s_add_u32 s63, s63, s50
    s_mul_i32 s63, s63, 896
    v_mfma_f32_16x16x32_bf16 v[66:69], v[110:113], v[146:149], v[66:69]
    s_lshl_b32 s54, s35, 7
    s_add_u32 s63, s63, s54
    v_mfma_f32_16x16x32_bf16 v[50:53], v[106:109], v[146:149], v[50:53]
    s_and_b32 s54, s38, 2
    s_lshl_b32 s54, s54, 5
    v_mfma_f32_16x16x32_bf16 v[82:85], v[114:117], v[146:149], v[82:85]
    s_add_u32 s63, s63, s54
    s_waitcnt lgkmcnt(9)
    v_mfma_f32_16x16x32_bf16 v[22:25], v[86:89], v[118:121], v[22:25]
    ds_read_b128 v[134:137], v12 offset:0
    ds_read_b64_tr_b16 v[102:103], v16 offset:0
    s_waitcnt lgkmcnt(9)
    v_mfma_f32_16x16x32_bf16 v[54:57], v[94:97], v[118:121], v[54:57]
    s_add_u32 m0, s44, 81920
    s_add_u32 s49, s41, s94
    buffer_load_dwordx4 v7, s[4:7], s49 offen offset:1024 lds
    v_mfma_f32_16x16x32_bf16 v[150:153], v[86:89], v[158:161], v[150:153]
    ds_read_b64_tr_b16 v[104:105], v16 offset:512
    v_mfma_f32_16x16x32_bf16 v[154:157], v[94:97], v[158:161], v[154:157]
    ds_read_b64_tr_b16 v[110:111], v16 offset:1024
    ds_read_b64_tr_b16 v[112:113], v16 offset:1536
    s_waitcnt lgkmcnt(9)
    v_mfma_f32_16x16x32_bf16 v[38:41], v[90:93], v[118:121], v[38:41]
    ds_read_b128 v[138:141], v12 offset:2048
    s_waitcnt lgkmcnt(8)
    v_mfma_f32_16x16x32_bf16 v[70:73], v[98:101], v[118:121], v[70:73]
    s_add_u32 m0, s44, 81920
    s_add_u32 s49, s42, s94
    buffer_load_dwordx4 v6, s[4:7], s49 offen offset:2048 lds
    v_mfma_f32_16x16x32_bf16 v[26:29], v[86:89], v[122:125], v[26:29]
    ds_read_b64_tr_b16 v[106:107], v17 offset:0
    v_mfma_f32_16x16x32_bf16 v[58:61], v[94:97], v[122:125], v[58:61]
    ds_read_b64_tr_b16 v[108:109], v17 offset:512
    ds_read_b64_tr_b16 v[114:115], v17 offset:1024
    v_mfma_f32_16x16x32_bf16 v[42:45], v[90:93], v[122:125], v[42:45]
    ds_read_b64_tr_b16 v[116:117], v17 offset:1536
    v_mfma_f32_16x16x32_bf16 v[74:77], v[98:101], v[122:125], v[74:77]
    s_add_u32 m0, s44, 81920
    s_add_u32 s49, s43, s94
    buffer_load_dwordx4 v7, s[4:7], s49 offen offset:3072 lds
    s_waitcnt lgkmcnt(11)
    v_mfma_f32_16x16x32_bf16 v[30:33], v[86:89], v[126:129], v[30:33]
    ds_read_b128 v[142:145], v12 offset:4096
    ds_read_b128 v[146:149], v12 offset:6144
    v_mfma_f32_16x16x32_bf16 v[62:65], v[94:97], v[126:129], v[62:65]
    ds_read_b64_tr_b16 v[166:167], v18 offset:0
    v_mfma_f32_16x16x32_bf16 v[46:49], v[90:93], v[126:129], v[46:49]
    ds_read_b64_tr_b16 v[168:169], v18 offset:2048
    v_mfma_f32_16x16x32_bf16 v[78:81], v[98:101], v[126:129], v[78:81]
    ds_read_b64_tr_b16 v[170:171], v19 offset:0
    s_waitcnt lgkmcnt(15)
    v_mfma_f32_16x16x32_bf16 v[34:37], v[86:89], v[130:133], v[34:37]
    ds_read_b64_tr_b16 v[172:173], v19 offset:2048
    ds_read_b64_tr_b16 v[174:175], v20 offset:0
    v_mfma_f32_16x16x32_bf16 v[66:69], v[94:97], v[130:133], v[66:69]
    ds_read_b64_tr_b16 v[176:177], v20 offset:2048
    v_mfma_f32_16x16x32_bf16 v[50:53], v[90:93], v[130:133], v[50:53]
    ds_read_b64_tr_b16 v[178:179], v21 offset:0
    v_mfma_f32_16x16x32_bf16 v[82:85], v[98:101], v[130:133], v[82:85]
    ds_read_b64_tr_b16 v[180:181], v21 offset:2048
    s_waitcnt lgkmcnt(15)
    v_mfma_f32_16x16x32_bf16 v[22:25], v[102:105], v[134:137], v[22:25]
    s_waitcnt vmcnt(6)
    s_waitcnt lgkmcnt(0)
    s_barrier
    ds_read_b128 v[118:121], v10 offset:32768
    v_mfma_f32_16x16x32_bf16 v[54:57], v[110:113], v[134:137], v[54:57]
    ds_read_b64_tr_b16 v[86:87], v14 offset:16384
    v_mfma_f32_16x16x32_bf16 v[38:41], v[106:109], v[134:137], v[38:41]
    s_mul_i32 s49, s90, 224
    s_add_u32 m0, s53, 0
    s_add_u32 s49, s49, s51
    buffer_load_dwordx4 v9, s[20:23], s49 offen offset:0 lds
    ds_read_b64_tr_b16 v[88:89], v14 offset:16896
    v_mfma_f32_16x16x32_bf16 v[70:73], v[114:117], v[134:137], v[70:73]
    ds_read_b64_tr_b16 v[94:95], v14 offset:17408
    v_mfma_f32_16x16x32_bf16 v[26:29], v[102:105], v[138:141], v[26:29]
    ds_read_b64_tr_b16 v[96:97], v14 offset:17920
    s_mul_i32 s49, s90, 224
    s_add_u32 m0, s53, 0
    s_add_u32 s49, s49, s52
    buffer_load_dwordx4 v9, s[20:23], s49 offen offset:1024 lds
    v_mfma_f32_16x16x32_bf16 v[58:61], v[110:113], v[138:141], v[58:61]
    ds_read_b128 v[122:125], v10 offset:34816
    v_mfma_f32_16x16x32_bf16 v[42:45], v[106:109], v[138:141], v[42:45]
    ds_read_b64_tr_b16 v[90:91], v15 offset:16384
    ds_read_b64_tr_b16 v[92:93], v15 offset:16896
    v_mfma_f32_16x16x32_bf16 v[74:77], v[114:117], v[138:141], v[74:77]
    s_mul_i32 s49, s95, 1792
    s_add_u32 m0, s46, 114688
    s_add_u32 s49, s49, s45
    buffer_load_dwordx4 v8, s[8:11], s49 offen lds
    v_mfma_f32_16x16x32_bf16 v[30:33], v[102:105], v[142:145], v[30:33]
    ds_read_b64_tr_b16 v[98:99], v15 offset:17408
    v_mfma_f32_16x16x32_bf16 v[62:65], v[110:113], v[142:145], v[62:65]
    ds_read_b64_tr_b16 v[100:101], v15 offset:17920
    ds_read_b128 v[126:129], v10 offset:36864
    v_mfma_f32_16x16x32_bf16 v[46:49], v[106:109], v[142:145], v[46:49]
    s_mul_i32 s49, s95, 1792
    s_add_u32 m0, s46, 115712
    s_add_u32 s49, s49, s45
    buffer_load_dwordx4 v8, s[12:15], s49 offen lds
    v_mfma_f32_16x16x32_bf16 v[78:81], v[114:117], v[142:145], v[78:81]
    ds_read_b128 v[130:133], v10 offset:38912
    s_lshl_b32 s32, s50, 16
    v_mfma_f32_16x16x32_bf16 v[34:37], v[102:105], v[146:149], v[34:37]
    s_lshl_b32 s54, s3, 13
    v_mfma_f32_16x16x32_bf16 v[66:69], v[110:113], v[146:149], v[66:69]
    s_add_u32 s32, s32, s54
    s_add_u32 s32, s32, 10485760
    v_mfma_f32_16x16x32_bf16 v[50:53], v[106:109], v[146:149], v[50:53]
    s_add_u32 s47, s32, 3072
    v_mfma_f32_16x16x32_bf16 v[82:85], v[114:117], v[146:149], v[82:85]
    v_mov_b32 v246, 0
    s_waitcnt lgkmcnt(9)
    v_mfma_f32_16x16x32_bf16 v[22:25], v[86:89], v[118:121], v[22:25]
    ds_read_b128 v[134:137], v12 offset:32768
    s_waitcnt lgkmcnt(8)
    v_mfma_f32_16x16x32_bf16 v[54:57], v[94:97], v[118:121], v[54:57]
    s_add_u32 m0, s44, 16384
    s_add_u32 s49, s40, s95
    buffer_load_dwordx4 v6, s[4:7], s49 offen offset:0 lds
    v_mfma_f32_16x16x32_bf16 v[150:153], v[86:89], v[158:161], v[150:153]
    ds_read_b64_tr_b16 v[102:103], v16 offset:16384
    v_mfma_f32_16x16x32_bf16 v[154:157], v[94:97], v[158:161], v[154:157]
    ds_read_b64_tr_b16 v[104:105], v16 offset:16896
    s_waitcnt lgkmcnt(7)
    v_mfma_f32_16x16x32_bf16 v[38:41], v[90:93], v[118:121], v[38:41]
    ds_read_b64_tr_b16 v[110:111], v16 offset:17408
    s_waitcnt lgkmcnt(6)
    v_mfma_f32_16x16x32_bf16 v[70:73], v[98:101], v[118:121], v[70:73]
    s_add_u32 m0, s44, 16384
    s_add_u32 s49, s41, s95
    buffer_load_dwordx4 v7, s[4:7], s49 offen offset:1024 lds
    v_mfma_f32_16x16x32_bf16 v[26:29], v[86:89], v[122:125], v[26:29]
    ds_read_b64_tr_b16 v[112:113], v16 offset:17920
    v_mfma_f32_16x16x32_bf16 v[58:61], v[94:97], v[122:125], v[58:61]
    ds_read_b128 v[138:141], v12 offset:34816
    v_mfma_f32_16x16x32_bf16 v[42:45], v[90:93], v[122:125], v[42:45]
    s_add_u32 m0, s44, 16384
    s_add_u32 s49, s42, s95
    buffer_load_dwordx4 v6, s[4:7], s49 offen offset:2048 lds
    v_mfma_f32_16x16x32_bf16 v[74:77], v[98:101], v[122:125], v[74:77]
    ds_read_b64_tr_b16 v[106:107], v17 offset:16384
    s_waitcnt lgkmcnt(8)
    v_mfma_f32_16x16x32_bf16 v[30:33], v[86:89], v[126:129], v[30:33]
    ds_read_b64_tr_b16 v[108:109], v17 offset:16896
    v_mfma_f32_16x16x32_bf16 v[62:65], v[94:97], v[126:129], v[62:65]
    s_add_u32 m0, s44, 16384
    s_add_u32 s49, s43, s95
    buffer_load_dwordx4 v7, s[4:7], s49 offen offset:3072 lds
    v_mfma_f32_16x16x32_bf16 v[46:49], v[90:93], v[126:129], v[46:49]
    ds_read_b64_tr_b16 v[114:115], v17 offset:17408
    v_mfma_f32_16x16x32_bf16 v[78:81], v[98:101], v[126:129], v[78:81]
    ds_read_b64_tr_b16 v[116:117], v17 offset:17920
    s_waitcnt lgkmcnt(10)
    v_mfma_f32_16x16x32_bf16 v[34:37], v[86:89], v[130:133], v[34:37]
    ds_read_b128 v[142:145], v12 offset:36864
    v_mfma_f32_16x16x32_bf16 v[66:69], v[94:97], v[130:133], v[66:69]
    buffer_load_dword v248, v247, s[28:31], 0 offen sc1
    v_mfma_f32_16x16x32_bf16 v[50:53], v[90:93], v[130:133], v[50:53]
    ds_read_b128 v[146:149], v12 offset:38912
    v_mfma_f32_16x16x32_bf16 v[82:85], v[98:101], v[130:133], v[82:85]
    s_waitcnt lgkmcnt(9)
    v_mfma_f32_16x16x32_bf16 v[22:25], v[102:105], v[134:137], v[22:25]
    s_waitcnt vmcnt(9)
    s_waitcnt vmcnt(7)
    s_waitcnt lgkmcnt(0)
    s_barrier
    ds_read_b128 v[118:121], v11 offset:0
    v_mfma_f32_16x16x32_bf16 v[54:57], v[110:113], v[134:137], v[54:57]
    ds_read_b64_tr_b16 v[86:87], v14 offset:32768
    v_mfma_f32_16x16x32_bf16 v[38:41], v[106:109], v[134:137], v[38:41]
    s_mul_i32 s49, s91, 224
    s_add_u32 m0, s53, 49152
    s_add_u32 s49, s49, s51
    buffer_load_dwordx4 v9, s[20:23], s49 offen offset:0 lds
    v_mfma_f32_16x16x32_bf16 v[70:73], v[114:117], v[134:137], v[70:73]
    ds_read_b64_tr_b16 v[88:89], v14 offset:33280
    v_mfma_f32_16x16x32_bf16 v[26:29], v[102:105], v[138:141], v[26:29]
    ds_read_b64_tr_b16 v[94:95], v14 offset:33792
    v_mfma_f32_16x16x32_bf16 v[58:61], v[110:113], v[138:141], v[58:61]
    ds_read_b64_tr_b16 v[96:97], v14 offset:34304
    v_mfma_f32_16x16x32_bf16 v[42:45], v[106:109], v[138:141], v[42:45]
    s_mul_i32 s49, s91, 224
    s_add_u32 m0, s53, 49152
    s_add_u32 s49, s49, s52
    buffer_load_dwordx4 v9, s[20:23], s49 offen offset:1024 lds
    v_mfma_f32_16x16x32_bf16 v[74:77], v[114:117], v[138:141], v[74:77]
    ds_read_b128 v[122:125], v11 offset:2048
    v_mfma_f32_16x16x32_bf16 v[30:33], v[102:105], v[142:145], v[30:33]
    ds_read_b64_tr_b16 v[90:91], v15 offset:32768
    v_mfma_f32_16x16x32_bf16 v[62:65], v[110:113], v[142:145], v[62:65]
    ds_read_b64_tr_b16 v[92:93], v15 offset:33280
    v_mfma_f32_16x16x32_bf16 v[46:49], v[106:109], v[142:145], v[46:49]
    s_mul_i32 s49, s92, 224
    s_add_u32 m0, s53, 65536
    s_add_u32 s49, s49, s51
    buffer_load_dwordx4 v9, s[20:23], s49 offen offset:0 lds
    v_mfma_f32_16x16x32_bf16 v[78:81], v[114:117], v[142:145], v[78:81]
    ds_read_b64_tr_b16 v[98:99], v15 offset:33792
    v_mfma_f32_16x16x32_bf16 v[34:37], v[102:105], v[146:149], v[34:37]
    ds_read_b64_tr_b16 v[100:101], v15 offset:34304
    v_mfma_f32_16x16x32_bf16 v[66:69], v[110:113], v[146:149], v[66:69]
    ds_read_b128 v[126:129], v11 offset:4096
    v_mfma_f32_16x16x32_bf16 v[50:53], v[106:109], v[146:149], v[50:53]
    s_mul_i32 s49, s92, 224
    s_add_u32 m0, s53, 65536
    s_add_u32 s49, s49, s52
    buffer_load_dwordx4 v9, s[20:23], s49 offen offset:1024 lds
    v_mfma_f32_16x16x32_bf16 v[82:85], v[114:117], v[146:149], v[82:85]
    ds_read_b128 v[130:133], v11 offset:6144
    s_waitcnt lgkmcnt(9)
    v_mfma_f32_16x16x32_bf16 v[22:25], v[86:89], v[118:121], v[22:25]
    ds_read_b128 v[134:137], v13 offset:0
    ds_read_b64_tr_b16 v[102:103], v16 offset:32768
    s_waitcnt lgkmcnt(9)
    v_mfma_f32_16x16x32_bf16 v[54:57], v[94:97], v[118:121], v[54:57]
    s_mul_i32 s49, s93, 224
    s_add_u32 m0, s53, 131072
    s_add_u32 s49, s49, s51
    buffer_load_dwordx4 v9, s[20:23], s49 offen offset:0 lds
    v_mfma_f32_16x16x32_bf16 v[150:153], v[86:89], v[158:161], v[150:153]
    ds_read_b64_tr_b16 v[104:105], v16 offset:33280
    v_mfma_f32_16x16x32_bf16 v[154:157], v[94:97], v[158:161], v[154:157]
    ds_read_b64_tr_b16 v[110:111], v16 offset:33792
    ds_read_b64_tr_b16 v[112:113], v16 offset:34304
    s_waitcnt lgkmcnt(9)
    v_mfma_f32_16x16x32_bf16 v[38:41], v[90:93], v[118:121], v[38:41]
    ds_read_b128 v[138:141], v13 offset:2048
    s_waitcnt lgkmcnt(8)
    v_mfma_f32_16x16x32_bf16 v[70:73], v[98:101], v[118:121], v[70:73]
    s_mul_i32 s49, s93, 224
    s_add_u32 m0, s53, 131072
    s_add_u32 s49, s49, s52
    buffer_load_dwordx4 v9, s[20:23], s49 offen offset:1024 lds
    v_mfma_f32_16x16x32_bf16 v[26:29], v[86:89], v[122:125], v[26:29]
    ds_read_b64_tr_b16 v[106:107], v17 offset:32768
    v_mfma_f32_16x16x32_bf16 v[58:61], v[94:97], v[122:125], v[58:61]
    ds_read_b64_tr_b16 v[108:109], v17 offset:33280
    ds_read_b64_tr_b16 v[114:115], v17 offset:33792
    v_mfma_f32_16x16x32_bf16 v[42:45], v[90:93], v[122:125], v[42:45]
    ds_read_b64_tr_b16 v[116:117], v17 offset:34304
    v_mfma_f32_16x16x32_bf16 v[74:77], v[98:101], v[122:125], v[74:77]
    s_mov_b32 s99, 0
    s_waitcnt vmcnt(6)
    v_cmp_ne_u32 vcc, 1, v248
    s_nop 0
    s_and_b64 vcc, vcc, -1
    s_cbranch_scc0 SP1_D
    s_mov_b64 exec, -1
SP1:
    buffer_load_dword v248, v247, s[28:31], 0 offen sc1
    s_add_u32 s99, s99, 1
    s_waitcnt vmcnt(0)
    v_cmp_ne_u32 vcc, 1, v248
    s_nop 1
    s_cmp_eq_u64 vcc, 0
    s_cbranch_scc1 SP1_E
    s_cmp_lt_u32 s99, 131072
    s_cbranch_scc1 SP1
SP1_E:
    s_mov_b64 exec, -1
SP1_D:
    buffer_load_dwordx4 v[162:165], v249, s[16:19], s56 offen sc1
    buffer_load_dword v250, v246, s[16:19], s61 offen sc1
    s_waitcnt lgkmcnt(11)
    v_mfma_f32_16x16x32_bf16 v[30:33], v[86:89], v[126:129], v[30:33]
    ds_read_b128 v[142:145], v13 offset:4096
    ds_read_b128 v[146:149], v13 offset:6144
    v_mfma_f32_16x16x32_bf16 v[62:65], v[94:97], v[126:129], v[62:65]
    ds_read_b64_tr_b16 v[182:183], v18 offset:0
    v_mfma_f32_16x16x32_bf16 v[46:49], v[90:93], v[126:129], v[46:49]
    ds_read_b64_tr_b16 v[184:185], v18 offset:2048
    v_mfma_f32_16x16x32_bf16 v[78:81], v[98:101], v[126:129], v[78:81]
    ds_read_b64_tr_b16 v[186:187], v19 offset:0
    s_waitcnt lgkmcnt(15)
    v_mfma_f32_16x16x32_bf16 v[34:37], v[86:89], v[130:133], v[34:37]
    ds_read_b64_tr_b16 v[188:189], v19 offset:2048
    ds_read_b64_tr_b16 v[190:191], v20 offset:0
    v_mfma_f32_16x16x32_bf16 v[66:69], v[94:97], v[130:133], v[66:69]
    ds_read_b64_tr_b16 v[192:193], v20 offset:2048
    v_mfma_f32_16x16x32_bf16 v[50:53], v[90:93], v[130:133], v[50:53]
    ds_read_b64_tr_b16 v[194:195], v21 offset:0
    v_mfma_f32_16x16x32_bf16 v[82:85], v[98:101], v[130:133], v[82:85]
    ds_read_b64_tr_b16 v[196:197], v21 offset:2048
    s_waitcnt lgkmcnt(15)
    v_mfma_f32_16x16x32_bf16 v[22:25], v[102:105], v[134:137], v[22:25]
    s_waitcnt vmcnt(2)
    s_waitcnt lgkmcnt(0)
    s_barrier
    ds_read_b128 v[118:121], v10 offset:0
    ds_read_b64_tr_b16 v[86:87], v14 offset:0
    v_mfma_f32_16x16x32_bf16 v[54:57], v[110:113], v[134:137], v[54:57]
    s_mul_i32 s49, s94, 224
    s_add_u32 m0, s53, 147456
    s_add_u32 s49, s49, s51
    buffer_load_dwordx4 v9, s[20:23], s49 offen offset:0 lds
    ds_read_b64_tr_b16 v[88:89], v14 offset:512
    v_mfma_f32_16x16x32_bf16 v[38:41], v[106:109], v[134:137], v[38:41]
    ds_read_b64_tr_b16 v[94:95], v14 offset:1024
    ds_read_b64_tr_b16 v[96:97], v14 offset:1536
    v_mfma_f32_16x16x32_bf16 v[70:73], v[114:117], v[134:137], v[70:73]
    s_mul_i32 s49, s94, 224
    s_add_u32 m0, s53, 147456
    s_add_u32 s49, s49, s52
    buffer_load_dwordx4 v9, s[20:23], s49 offen offset:1024 lds
    ds_read_b128 v[122:125], v10 offset:2048
    v_mfma_f32_16x16x32_bf16 v[26:29], v[102:105], v[138:141], v[26:29]
    ds_read_b64_tr_b16 v[90:91], v15 offset:0
    ds_read_b64_tr_b16 v[92:93], v15 offset:512
    v_mfma_f32_16x16x32_bf16 v[58:61], v[110:113], v[138:141], v[58:61]
    s_mul_i32 s49, s95, 224
    s_add_u32 m0, s53, 98304
    s_add_u32 s49, s49, s51
    buffer_load_dwordx4 v9, s[20:23], s49 offen offset:0 lds
    ds_read_b64_tr_b16 v[98:99], v15 offset:1024
    v_mfma_f32_16x16x32_bf16 v[42:45], v[106:109], v[138:141], v[42:45]
    ds_read_b64_tr_b16 v[100:101], v15 offset:1536
    ds_read_b128 v[126:129], v10 offset:4096
    v_mfma_f32_16x16x32_bf16 v[74:77], v[114:117], v[138:141], v[74:77]
    s_mul_i32 s49, s95, 224
    s_add_u32 m0, s53, 98304
    s_add_u32 s49, s49, s52
    buffer_load_dwordx4 v9, s[20:23], s49 offen offset:1024 lds
    ds_read_b128 v[130:133], v10 offset:6144
    v_mfma_f32_16x16x32_bf16 v[30:33], v[102:105], v[142:145], v[30:33]
    ds_read_b64_tr_b16 v[198:199], v18 offset:49152
    ds_read_b64_tr_b16 v[200:201], v18 offset:51200
    v_mfma_f32_16x16x32_bf16 v[62:65], v[110:113], v[142:145], v[62:65]
    ds_read_b64_tr_b16 v[202:203], v19 offset:49152
    ds_read_b64_tr_b16 v[204:205], v19 offset:51200
    v_mfma_f32_16x16x32_bf16 v[46:49], v[106:109], v[142:145], v[46:49]
    ds_read_b64_tr_b16 v[206:207], v20 offset:49152
    ds_read_b64_tr_b16 v[208:209], v20 offset:51200
    v_mfma_f32_16x16x32_bf16 v[78:81], v[114:117], v[142:145], v[78:81]
    ds_read_b64_tr_b16 v[210:211], v21 offset:49152
    ds_read_b64_tr_b16 v[212:213], v21 offset:51200
    v_mfma_f32_16x16x32_bf16 v[34:37], v[102:105], v[146:149], v[34:37]
    v_add_u32 v18, 0x10000, v18
    v_add_u32 v19, 0x10000, v19
    v_mfma_f32_16x16x32_bf16 v[66:69], v[110:113], v[146:149], v[66:69]
    v_add_u32 v20, 0x10000, v20
    v_add_u32 v21, 0x10000, v21
    v_mfma_f32_16x16x32_bf16 v[50:53], v[106:109], v[146:149], v[50:53]
    ds_read_b64_tr_b16 v[214:215], v18 offset:0
    ds_read_b64_tr_b16 v[216:217], v18 offset:2048
    v_mfma_f32_16x16x32_bf16 v[82:85], v[114:117], v[146:149], v[82:85]
    ds_read_b64_tr_b16 v[218:219], v19 offset:0
    ds_read_b64_tr_b16 v[220:221], v19 offset:2048
    s_waitcnt lgkmcnt(15)
    v_mfma_f32_16x16x32_bf16 v[22:25], v[86:89], v[118:121], v[22:25]
    ds_read_b128 v[134:137], v12 offset:0
    ds_read_b64_tr_b16 v[102:103], v16 offset:0
    v_mfma_f32_16x16x32_bf16 v[54:57], v[94:97], v[118:121], v[54:57]
    ds_read_b64_tr_b16 v[104:105], v16 offset:512
    s_mul_i32 s49, s89, 224
    s_mul_i32 s64, s65, 802816
    s_add_u32 s51, s51, s64
    s_add_u32 m0, s53, 81920
    s_add_u32 s49, s49, s51
    buffer_load_dwordx4 v9, s[20:23], s49 offen offset:0 lds
    v_mfma_f32_16x16x32_bf16 v[150:153], v[86:89], v[158:161], v[150:153]
    ds_read_b64_tr_b16 v[110:111], v16 offset:1024
    ds_read_b64_tr_b16 v[112:113], v16 offset:1536
    v_mfma_f32_16x16x32_bf16 v[154:157], v[94:97], v[158:161], v[154:157]
    ds_read_b128 v[138:141], v12 offset:2048
    ds_read_b64_tr_b16 v[106:107], v17 offset:0
    v_mfma_f32_16x16x32_bf16 v[38:41], v[90:93], v[118:121], v[38:41]
    ds_read_b64_tr_b16 v[108:109], v17 offset:512
    ds_read_b64_tr_b16 v[114:115], v17 offset:1024
    s_waitcnt lgkmcnt(15)
    v_mfma_f32_16x16x32_bf16 v[70:73], v[98:101], v[118:121], v[70:73]
    s_mul_i32 s49, s89, 224
    s_mul_i32 s64, s65, 802816
    s_add_u32 s52, s52, s64
    s_add_u32 m0, s53, 81920
    s_add_u32 s49, s49, s52
    buffer_load_dwordx4 v9, s[20:23], s49 offen offset:1024 lds
    ds_read_b64_tr_b16 v[116:117], v17 offset:1536
    v_mfma_f32_16x16x32_bf16 v[26:29], v[86:89], v[122:125], v[26:29]
    ds_read_b128 v[142:145], v12 offset:4096
    ds_read_b128 v[146:149], v12 offset:6144
    v_mfma_f32_16x16x32_bf16 v[58:61], v[94:97], v[122:125], v[58:61]
    ds_read_b64_tr_b16 v[222:223], v20 offset:0
    ds_read_b64_tr_b16 v[224:225], v20 offset:2048
    v_mfma_f32_16x16x32_bf16 v[42:45], v[90:93], v[122:125], v[42:45]
    ds_read_b64_tr_b16 v[226:227], v21 offset:0
    v_mfma_f32_16x16x32_bf16 v[74:77], v[98:101], v[122:125], v[74:77]
    ds_read_b64_tr_b16 v[228:229], v21 offset:2048
    v_add_u32 v18, 0x8000, v18
    v_mfma_f32_16x16x32_bf16 v[30:33], v[86:89], v[126:129], v[30:33]
    v_add_u32 v19, 0x8000, v19
    v_add_u32 v20, 0x8000, v20
    v_mfma_f32_16x16x32_bf16 v[62:65], v[94:97], v[126:129], v[62:65]
    v_add_u32 v21, 0x8000, v21
    ds_read_b64_tr_b16 v[230:231], v18 offset:32768
    v_mfma_f32_16x16x32_bf16 v[46:49], v[90:93], v[126:129], v[46:49]
    ds_read_b64_tr_b16 v[232:233], v18 offset:34816
    ds_read_b64_tr_b16 v[234:235], v19 offset:32768
    v_mfma_f32_16x16x32_bf16 v[78:81], v[98:101], v[126:129], v[78:81]
    ds_read_b64_tr_b16 v[236:237], v19 offset:34816
    ds_read_b64_tr_b16 v[238:239], v20 offset:32768
    v_mfma_f32_16x16x32_bf16 v[34:37], v[86:89], v[130:133], v[34:37]
    ds_read_b64_tr_b16 v[240:241], v20 offset:34816
    ds_read_b64_tr_b16 v[242:243], v21 offset:32768
    v_mfma_f32_16x16x32_bf16 v[66:69], v[94:97], v[130:133], v[66:69]
    ds_read_b64_tr_b16 v[244:245], v21 offset:34816
    s_lshl_b32 s54, s3, 11
    v_mfma_f32_16x16x32_bf16 v[50:53], v[90:93], v[130:133], v[50:53]
    v_add_u32 v3, s54, v2
    ds_write_b128 v3, v[150:153]
    v_mfma_f32_16x16x32_bf16 v[82:85], v[98:101], v[130:133], v[82:85]
    ds_write_b128 v3, v[154:157] offset:1024
    s_waitcnt lgkmcnt(15)
    v_mfma_f32_16x16x32_bf16 v[22:25], v[102:105], v[134:137], v[22:25]
    s_waitcnt lgkmcnt(0)
    s_barrier
    s_cmp_ge_u32 s38, 2
    s_cbranch_scc1 NOPR
    s_setprio 2
NOPR:
    s_mul_i32 s49, s90, 224
    s_add_u32 m0, s53, 114688
    s_add_u32 s49, s49, s51
    buffer_load_dwordx4 v9, s[20:23], s49 offen offset:0 lds
    v_mfma_f32_16x16x32_bf16 v[54:57], v[110:113], v[134:137], v[54:57]
    s_mul_i32 s49, s90, 224
    s_add_u32 m0, s53, 114688
    s_add_u32 s49, s49, s52
    buffer_load_dwordx4 v9, s[20:23], s49 offen offset:1024 lds
    v_mfma_f32_16x16x32_bf16 v[38:41], v[106:109], v[134:137], v[38:41]
    s_mul_i32 s49, s91, 224
    s_add_u32 m0, s53, 131072
    s_add_u32 s49, s49, s51
    buffer_load_dwordx4 v9, s[20:23], s49 offen offset:0 lds
    v_mfma_f32_16x16x32_bf16 v[70:73], v[114:117], v[134:137], v[70:73]
    s_mul_i32 s49, s91, 224
    s_add_u32 m0, s53, 131072
    s_add_u32 s49, s49, s52
    buffer_load_dwordx4 v9, s[20:23], s49 offen offset:1024 lds
    v_mfma_f32_16x16x32_bf16 v[26:29], v[102:105], v[138:141], v[26:29]
    s_mul_i32 s49, s92, 224
    s_add_u32 m0, s53, 16384
    s_add_u32 s49, s49, s51
    buffer_load_dwordx4 v9, s[20:23], s49 offen offset:0 lds
    v_mfma_f32_16x16x32_bf16 v[58:61], v[110:113], v[138:141], v[58:61]
    s_mul_i32 s49, s92, 224
    s_add_u32 m0, s53, 16384
    s_add_u32 s49, s49, s52
    buffer_load_dwordx4 v9, s[20:23], s49 offen offset:1024 lds
    s_and_b32 s54, s3, 5
    v_mfma_f32_16x16x32_bf16 v[42:45], v[106:109], v[138:141], v[42:45]
    s_lshl_b32 s54, s54, 11
    v_mfma_f32_16x16x32_bf16 v[74:77], v[114:117], v[138:141], v[74:77]
    v_add_u32 v3, s54, v2
    v_mfma_f32_16x16x32_bf16 v[30:33], v[102:105], v[142:145], v[30:33]
    v_xor_b32 v4, 0x800, v3
    v_mfma_f32_16x16x32_bf16 v[62:65], v[110:113], v[142:145], v[62:65]
    ds_read_b128 v[86:89], v3 offset:0
    v_mfma_f32_16x16x32_bf16 v[46:49], v[106:109], v[142:145], v[46:49]
    ds_read_b128 v[118:121], v3 offset:4096
    ds_read_b128 v[94:97], v3 offset:1024
    v_mfma_f32_16x16x32_bf16 v[78:81], v[114:117], v[142:145], v[78:81]
    ds_read_b128 v[126:129], v3 offset:5120
    v_mfma_f32_16x16x32_bf16 v[34:37], v[102:105], v[146:149], v[34:37]
    ds_read_b128 v[90:93], v4 offset:0
    v_mfma_f32_16x16x32_bf16 v[66:69], v[110:113], v[146:149], v[66:69]
    ds_read_b128 v[122:125], v4 offset:4096
    v_mfma_f32_16x16x32_bf16 v[50:53], v[106:109], v[146:149], v[50:53]
    ds_read_b128 v[98:101], v4 offset:1024
    v_mfma_f32_16x16x32_bf16 v[82:85], v[114:117], v[146:149], v[82:85]
    ds_read_b128 v[130:133], v4 offset:5120
PADF0:
    s_cbranch_execz PADF1
    s_waitcnt vmcnt(13)
PADF1:
    s_cbranch_execz PADF2
    v_lshlrev_b32 v110, 16, v162
    v_and_b32 v102, 0xffff0000, v162
    v_rcp_f32 v106, v110
    v_lshlrev_b32 v111, 16, v163
    v_and_b32 v103, 0xffff0000, v163
    v_rcp_f32 v107, v111
    v_lshlrev_b32 v112, 16, v164
    v_and_b32 v104, 0xffff0000, v164
    v_rcp_f32 v108, v112
    v_lshlrev_b32 v113, 16, v165
    v_and_b32 v105, 0xffff0000, v165
PADF2:
    s_cbranch_execz PADF3
    v_rcp_f32 v109, v113
    s_waitcnt lgkmcnt(6)
    v_add_f32 v86, v86, v118
    v_add_f32 v87, v87, v119
    v_add_f32 v88, v88, v120
    v_add_f32 v89, v89, v121
    s_waitcnt lgkmcnt(2)
    v_add_f32 v90, v90, v122
    v_add_f32 v91, v91, v123
    v_add_f32 v92, v92, v124
    v_add_f32 v93, v93, v125
    v_add_f32 v94, v94, v126
    v_add_f32 v95, v95, v127
    v_add_f32 v96, v96, v128
PADF3:
    s_cbranch_execz PADF4
    v_add_f32 v97, v97, v129
    s_waitcnt lgkmcnt(0)
    v_add_f32 v98, v98, v130
    v_add_f32 v99, v99, v131
    v_add_f32 v100, v100, v132
    v_add_f32 v101, v101, v133
    v_mul_f32 v110, v110, v110
    v_mul_f32 v106, 0xbfb8aa3b, v106
    v_mul_f32 v111, v111, v111
    v_mul_f32 v107, 0xbfb8aa3b, v107
    v_mul_f32 v112, v112, v112
    v_mul_f32 v108, 0xbfb8aa3b, v108
PADF4:
    s_cbranch_execz PADF5
    v_mul_f32 v113, v113, v113
    v_mul_f32 v109, 0xbfb8aa3b, v109
    v_fma_f32 v22, v86, v102, v22
    v_fma_f32 v23, v87, v102, v23
    v_fma_f32 v24, v88, v102, v24
    v_fma_f32 v25, v89, v102, v25
    v_fma_f32 v38, v90, v102, v38
    v_fma_f32 v39, v91, v102, v39
PADF5:
    s_cbranch_execz PADF6
    v_fma_f32 v40, v92, v102, v40
    v_fma_f32 v41, v93, v102, v41
    v_mul_f32 v118, v22, v106
    v_mul_f32 v119, v23, v106
    v_mul_f32 v120, v24, v106
    v_mul_f32 v121, v25, v106
    v_mul_f32 v122, v38, v106
    v_mul_f32 v123, v39, v106
    v_mul_f32 v124, v40, v106
    v_mul_f32 v125, v41, v106
    s_mul_i32 s49, s93, 224
    s_add_u32 m0, s53, 32768
PADF6:
    s_cbranch_execz PADF7
    s_add_u32 s49, s49, s51
    buffer_load_dwordx4 v9, s[20:23], s49 offen offset:0 lds
    v_fma_f32 v54, v94, v102, v54
    v_fma_f32 v55, v95, v102, v55
    v_fma_f32 v56, v96, v102, v56
    v_fma_f32 v57, v97, v102, v57
    v_fma_f32 v70, v98, v102, v70
    v_fma_f32 v71, v99, v102, v71
PADF7:
    s_cbranch_execz PADF8
    v_fma_f32 v72, v100, v102, v72
    v_fma_f32 v73, v101, v102, v73
    v_exp_f32 v118, v118
    v_exp_f32 v119, v119
    v_exp_f32 v120, v120
    v_exp_f32 v121, v121
    v_exp_f32 v122, v122
    v_exp_f32 v123, v123
    v_exp_f32 v124, v124
    v_exp_f32 v125, v125
    v_pk_mul_f32 v[54:55], v[54:55], v[22:23]
PADF8:
    s_cbranch_execz PADF9
    v_pk_mul_f32 v[56:57], v[56:57], v[24:25]
    v_pk_mul_f32 v[70:71], v[70:71], v[38:39]
    v_pk_mul_f32 v[72:73], v[72:73], v[40:41]
    v_pk_fma_f32 v[118:119], v[118:119], v[110:111], v[110:111] op_sel_hi:[1,0,0]
    v_pk_fma_f32 v[120:121], v[120:121], v[110:111], v[110:111] op_sel_hi:[1,0,0]
    v_pk_fma_f32 v[122:123], v[122:123], v[110:111], v[110:111] op_sel_hi:[1,0,0]
    v_pk_fma_f32 v[124:125], v[124:125], v[110:111], v[110:111] op_sel_hi:[1,0,0]
    s_mul_i32 s49, s93, 224
PADF9:
    s_cbranch_execz PADF10
    s_add_u32 m0, s53, 32768
    s_add_u32 s49, s49, s52
    buffer_load_dwordx4 v9, s[20:23], s49 offen offset:1024 lds
    v_rcp_f32 v118, v118
    v_rcp_f32 v119, v119
    v_rcp_f32 v120, v120
    v_rcp_f32 v121, v121
    v_rcp_f32 v122, v122
    v_rcp_f32 v123, v123
    v_rcp_f32 v124, v124
    v_rcp_f32 v125, v125
    v_pk_mul_f32 v[54:55], v[54:55], v[118:119]
PADF10:
    s_cbranch_execz PADF11
    v_pk_mul_f32 v[56:57], v[56:57], v[120:121]
    v_pk_mul_f32 v[70:71], v[70:71], v[122:123]
    v_pk_mul_f32 v[72:73], v[72:73], v[124:125]
    v_cvt_pk_bf16_f32 v134, v54, v55
    v_cvt_pk_bf16_f32 v135, v56, v57
    v_cvt_pk_bf16_f32 v136, v70, v71
    v_cvt_pk_bf16_f32 v137, v72, v73
PADF11:
    s_cbranch_execz RETF
    buffer_store_dwordx4 v[134:137], v2, s[16:19], s57 offen offset:0 sc1
    v_pk_fma_f32 v[26:27], v[86:87], v[102:103], v[26:27] op_sel:[0,1,0]
    v_pk_fma_f32 v[28:29], v[88:89], v[102:103], v[28:29] op_sel:[0,1,0]
    v_pk_fma_f32 v[42:43], v[90:91], v[102:103], v[42:43] op_sel:[0,1,0]
    v_pk_fma_f32 v[44:45], v[92:93], v[102:103], v[44:45] op_sel:[0,1,0]
    v_pk_mul_f32 v[126:127], v[26:27], v[106:107] op_sel:[0,1]
    v_pk_mul_f32 v[128:129], v[28:29], v[106:107] op_sel:[0,1]
    v_pk_mul_f32 v[130:131], v[42:43], v[106:107] op_sel:[0,1]
PADF12:
    s_cbranch_execz PADF13
    v_pk_mul_f32 v[132:133], v[44:45], v[106:107] op_sel:[0,1]
    s_mul_i32 s49, s94, 224
    s_add_u32 m0, s53, 49152
    s_add_u32 s49, s49, s51
    buffer_load_dwordx4 v9, s[20:23], s49 offen offset:0 lds
    v_pk_fma_f32 v[58:59], v[94:95], v[102:103], v[58:59] op_sel:[0,1,0]
    v_pk_fma_f32 v[60:61], v[96:97], v[102:103], v[60:61] op_sel:[0,1,0]
    v_pk_fma_f32 v[74:75], v[98:99], v[102:103], v[74:75] op_sel:[0,1,0]
PADF13:
    s_cbranch_execz PADF14
    v_pk_fma_f32 v[76:77], v[100:101], v[102:103], v[76:77] op_sel:[0,1,0]
    v_exp_f32 v126, v126
    v_exp_f32 v127, v127
    v_exp_f32 v128, v128
    v_exp_f32 v129, v129
    v_exp_f32 v130, v130
    v_exp_f32 v131, v131
    v_exp_f32 v132, v132
    v_exp_f32 v133, v133
    v_pk_mul_f32 v[58:59], v[58:59], v[26:27]
    v_pk_mul_f32 v[60:61], v[60:61], v[28:29]
PADF14:
    s_cbranch_execz PADF15
    v_pk_mul_f32 v[74:75], v[74:75], v[42:43]
    v_pk_mul_f32 v[76:77], v[76:77], v[44:45]
    v_pk_fma_f32 v[126:127], v[126:127], v[110:111], v[110:111] op_sel:[0,1,1]
    v_pk_fma_f32 v[128:129], v[128:129], v[110:111], v[110:111] op_sel:[0,1,1]
    v_pk_fma_f32 v[130:131], v[130:131], v[110:111], v[110:111] op_sel:[0,1,1]
    v_pk_fma_f32 v[132:133], v[132:133], v[110:111], v[110:111] op_sel:[0,1,1]
    s_mul_i32 s49, s94, 224
    s_add_u32 m0, s53, 49152
PADF15:
    s_cbranch_execz PADF16
    s_add_u32 s49, s49, s52
    buffer_load_dwordx4 v9, s[20:23], s49 offen offset:1024 lds
    v_rcp_f32 v126, v126
    v_rcp_f32 v127, v127
    v_rcp_f32 v128, v128
    v_rcp_f32 v129, v129
    v_rcp_f32 v130, v130
    v_rcp_f32 v131, v131
    v_rcp_f32 v132, v132
    v_rcp_f32 v133, v133
    v_pk_mul_f32 v[58:59], v[58:59], v[126:127]
    v_pk_mul_f32 v[60:61], v[60:61], v[128:129]
PADF16:
    s_cbranch_execz PADF17
    v_pk_mul_f32 v[74:75], v[74:75], v[130:131]
    v_pk_mul_f32 v[76:77], v[76:77], v[132:133]
    v_cvt_pk_bf16_f32 v138, v58, v59
    v_cvt_pk_bf16_f32 v139, v60, v61
    v_cvt_pk_bf16_f32 v140, v74, v75
    v_cvt_pk_bf16_f32 v141, v76, v77
    buffer_store_dwordx4 v[138:141], v2, s[16:19], s57 offen offset:1024 sc1
PADF17:
    s_cbranch_execz PADF18
    v_pk_fma_f32 v[30:31], v[86:87], v[104:105], v[30:31] op_sel_hi:[1,0,1]
    v_pk_fma_f32 v[32:33], v[88:89], v[104:105], v[32:33] op_sel_hi:[1,0,1]
    v_pk_fma_f32 v[46:47], v[90:91], v[104:105], v[46:47] op_sel_hi:[1,0,1]
    v_pk_fma_f32 v[48:49], v[92:93], v[104:105], v[48:49] op_sel_hi:[1,0,1]
    v_pk_mul_f32 v[118:119], v[30:31], v[108:109] op_sel_hi:[1,0]
    v_pk_mul_f32 v[120:121], v[32:33], v[108:109] op_sel_hi:[1,0]
    v_pk_mul_f32 v[122:123], v[46:47], v[108:109] op_sel_hi:[1,0]
    v_pk_mul_f32 v[124:125], v[48:49], v[108:109] op_sel_hi:[1,0]
PADF18:
    s_cbranch_execz PADF19
    s_mul_i32 s49, s95, 224
    s_add_u32 m0, s53, 65536
    s_add_u32 s49, s49, s51
    buffer_load_dwordx4 v9, s[20:23], s49 offen offset:0 lds
    v_pk_fma_f32 v[62:63], v[94:95], v[104:105], v[62:63] op_sel_hi:[1,0,1]
    v_pk_fma_f32 v[64:65], v[96:97], v[104:105], v[64:65] op_sel_hi:[1,0,1]
    v_pk_fma_f32 v[78:79], v[98:99], v[104:105], v[78:79] op_sel_hi:[1,0,1]
    v_pk_fma_f32 v[80:81], v[100:101], v[104:105], v[80:81] op_sel_hi:[1,0,1]
PADF19:
    s_cbranch_execz PADF20
    v_exp_f32 v118, v118
    v_exp_f32 v119, v119
    v_exp_f32 v120, v120
    v_exp_f32 v121, v121
    v_exp_f32 v122, v122
    v_exp_f32 v123, v123
    v_exp_f32 v124, v124
    v_exp_f32 v125, v125
    v_pk_mul_f32 v[62:63], v[62:63], v[30:31]
    v_pk_mul_f32 v[64:65], v[64:65], v[32:33]
    v_pk_mul_f32 v[78:79], v[78:79], v[46:47]
PADF20:
    s_cbranch_execz PADF21
    v_pk_mul_f32 v[80:81], v[80:81], v[48:49]
    v_pk_fma_f32 v[118:119], v[118:119], v[112:113], v[112:113] op_sel_hi:[1,0,0]
    v_pk_fma_f32 v[120:121], v[120:121], v[112:113], v[112:113] op_sel_hi:[1,0,0]
    v_pk_fma_f32 v[122:123], v[122:123], v[112:113], v[112:113] op_sel_hi:[1,0,0]
    v_pk_fma_f32 v[124:125], v[124:125], v[112:113], v[112:113] op_sel_hi:[1,0,0]
    s_mul_i32 s49, s95, 224
    s_add_u32 m0, s53, 65536
    s_add_u32 s49, s49, s52
PADF21:
    s_cbranch_execz PADF22
    buffer_load_dwordx4 v9, s[20:23], s49 offen offset:1024 lds
    v_rcp_f32 v118, v118
    v_rcp_f32 v119, v119
    v_rcp_f32 v120, v120
    v_rcp_f32 v121, v121
    v_rcp_f32 v122, v122
    v_rcp_f32 v123, v123
    v_rcp_f32 v124, v124
    v_rcp_f32 v125, v125
    v_pk_mul_f32 v[62:63], v[62:63], v[118:119]
    v_pk_mul_f32 v[64:65], v[64:65], v[120:121]
    v_pk_mul_f32 v[78:79], v[78:79], v[122:123]
PADF22:
    s_cbranch_execz PADF23
    v_pk_mul_f32 v[80:81], v[80:81], v[124:125]
    v_cvt_pk_bf16_f32 v142, v62, v63
    v_cvt_pk_bf16_f32 v143, v64, v65
    v_cvt_pk_bf16_f32 v144, v78, v79
    v_cvt_pk_bf16_f32 v145, v80, v81
    buffer_store_dwordx4 v[142:145], v2, s[16:19], s57 offen offset:2048 sc1
    v_pk_fma_f32 v[34:35], v[86:87], v[104:105], v[34:35] op_sel:[0,1,0]
PADF23:
    s_cbranch_execz RETF
    v_pk_fma_f32 v[36:37], v[88:89], v[104:105], v[36:37] op_sel:[0,1,0]
    v_pk_fma_f32 v[50:51], v[90:91], v[104:105], v[50:51] op_sel:[0,1,0]
    v_pk_fma_f32 v[52:53], v[92:93], v[104:105], v[52:53] op_sel:[0,1,0]
    v_pk_mul_f32 v[126:127], v[34:35], v[108:109] op_sel:[0,1]
    v_pk_mul_f32 v[128:129], v[36:37], v[108:109] op_sel:[0,1]
    v_pk_mul_f32 v[130:131], v[50:51], v[108:109] op_sel:[0,1]
    v_pk_mul_f32 v[132:133], v[52:53], v[108:109] op_sel:[0,1]
    v_pk_fma_f32 v[66:67], v[94:95], v[104:105], v[66:67] op_sel:[0,1,0]
PADF24:
    s_cbranch_execz PADF25
    v_pk_fma_f32 v[68:69], v[96:97], v[104:105], v[68:69] op_sel:[0,1,0]
    v_pk_fma_f32 v[82:83], v[98:99], v[104:105], v[82:83] op_sel:[0,1,0]
    v_pk_fma_f32 v[84:85], v[100:101], v[104:105], v[84:85] op_sel:[0,1,0]
    v_exp_f32 v126, v126
    v_exp_f32 v127, v127
    v_exp_f32 v128, v128
    v_exp_f32 v129, v129
    v_exp_f32 v130, v130
    v_exp_f32 v131, v131
    v_exp_f32 v132, v132
    v_exp_f32 v133, v133
PADF25:
    s_cbranch_execz PADF26
    v_pk_mul_f32 v[66:67], v[66:67], v[34:35]
    v_pk_mul_f32 v[68:69], v[68:69], v[36:37]
    v_pk_mul_f32 v[82:83], v[82:83], v[50:51]
    v_pk_mul_f32 v[84:85], v[84:85], v[52:53]
    v_pk_fma_f32 v[126:127], v[126:127], v[112:113], v[112:113] op_sel:[0,1,1]
    v_pk_fma_f32 v[128:129], v[128:129], v[112:113], v[112:113] op_sel:[0,1,1]
    v_pk_fma_f32 v[130:131], v[130:131], v[112:113], v[112:113] op_sel:[0,1,1]
    v_pk_fma_f32 v[132:133], v[132:133], v[112:113], v[112:113] op_sel:[0,1,1]
PADF26:
    s_cbranch_execz PADF27
    v_rcp_f32 v126, v126
    v_rcp_f32 v127, v127
    v_rcp_f32 v128, v128
    v_rcp_f32 v129, v129
    v_rcp_f32 v130, v130
    v_rcp_f32 v131, v131
    v_rcp_f32 v132, v132
    v_rcp_f32 v133, v133
    v_pk_mul_f32 v[66:67], v[66:67], v[126:127]
    v_pk_mul_f32 v[68:69], v[68:69], v[128:129]
    v_pk_mul_f32 v[82:83], v[82:83], v[130:131]
PADF27:
    s_cbranch_execz PADF28
    v_pk_mul_f32 v[84:85], v[84:85], v[132:133]
    v_cvt_pk_bf16_f32 v146, v66, v67
    v_cvt_pk_bf16_f32 v147, v68, v69
    v_cvt_pk_bf16_f32 v148, v82, v83
    v_cvt_pk_bf16_f32 v149, v84, v85
    buffer_store_dwordx4 v[146:149], v2, s[16:19], s57 offen offset:3072 sc1
    s_and_b32 s49, s38, 1
    s_lshl_b32 s49, s49, 10
    v_add_u32 v6, s49, v2
PADF28:
    s_cbranch_execz PADF29
    v_xor_b32 v7, 0x400, v6
    v_mov_b32 v13, 1
    v_lshlrev_b32 v8, 2, v1
    v_lshlrev_b32 v3, 7, v1
    s_mov_b32 exec_hi, 0
    buffer_load_dword v10, v8, s[16:19], s61 offen sc1
    s_mov_b32 exec_lo, 1
    s_waitcnt vmcnt(1)
    s_cmp_ge_u32 s38, 2
    s_cbranch_scc0 BX
    buffer_store_dword v13, off, s[16:19], s60 offset:128 sc1
    s_branch BY
BX:
PADF29:
    s_cbranch_execz PADF30
    buffer_store_dword v13, off, s[16:19], s60 offset:0
    s_mov_b32 exec_lo, -1
    s_waitcnt vmcnt(1)
    v_cmp_eq_u32 vcc, 1, v10
    s_nop 0
    s_andn2_b32 s54, 0x0fffffff, vcc_lo
    s_cbranch_scc0 SP2_D
    s_mov_b32 s99, 0
    s_mov_b32 exec_hi, 0
SP2:
    buffer_load_dword v10, v8, s[16:19], s61 offen offset:0 sc1
    s_add_u32 s99, s99, 1
    s_waitcnt vmcnt(0)
PADF30:
    s_cbranch_execz PADF31
    v_cmp_eq_u32 vcc, 1, v10
    s_nop 1
    s_or_b32 s54, vcc_lo, vcc_hi
    s_andn2_b32 s54, 0x0fffffff, s54
    s_cbranch_scc0 SP2_E
    s_cmp_lg_u32 s99, 24
    s_cbranch_scc1 SP2_C
    s_mov_b32 exec_lo, 1
    buffer_store_dword v13, off, s[16:19], s60 offset:128 sc1
    s_mov_b64 exec, -1
SP2_C:
    s_cmp_lt_u32 s99, 131072
    s_cbranch_scc1 SP2
SP2_E:
PADF31:
    s_cbranch_execz PADF32
    s_mov_b64 exec, -1
SP2_D:
BY:
    s_mov_b64 exec, -1
    s_barrier
    s_lshl_b32 s49, s89, 5
    s_add_u32 s49, s49, s59
    buffer_load_dwordx4 v[22:25], v6, s[16:19], s49 offen sc1
    buffer_load_dwordx4 v[26:29], v7, s[16:19], s49 offen sc1
    s_lshl_b32 s49, s90, 5
    s_add_u32 s49, s49, s59
    buffer_load_dwordx4 v[30:33], v6, s[16:19], s49 offen sc1
    buffer_load_dwordx4 v[34:37], v7, s[16:19], s49 offen sc1
PADF32:
    s_cbranch_execz PADF33
    s_lshl_b32 s49, s91, 5
    s_add_u32 s49, s49, s59
    buffer_load_dwordx4 v[38:41], v6, s[16:19], s49 offen sc1
    buffer_load_dwordx4 v[42:45], v7, s[16:19], s49 offen sc1
    s_lshl_b32 s54, s38, 7
    s_add_u32 s61, s61, s54
    s_setprio 0
    v_and_b32 v3, 15, v1
    v_mul_u32_u24 v11, 28672, v3
    v_lshl_add_u32 v11, v5, 3, v11
    s_lshl_b32 s54, s58, 4
PADF33:
    s_cbranch_execz PADF34
    v_add_u32 v3, s54, v3
    v_cvt_f32_u32 v3, v3
    v_mul_f32 v3, 0x3c800000, v3
    v_cvt_f32_u32 v94, v5
    v_mul_f32 v94, 4.0, v94
    v_mul_f32 v78, v94, v3
    v_fmamk_f32 v79, v3, 0x3f800000, v78
    v_fmamk_f32 v80, v3, 0x40000000, v78
    v_fmamk_f32 v81, v3, 0x40400000, v78
    v_fmamk_f32 v82, v3, 0x41800000, v78
PADF34:
    s_cbranch_execz PADF35
    v_fmamk_f32 v83, v3, 0x41880000, v78
    v_fmamk_f32 v84, v3, 0x41900000, v78
    v_fmamk_f32 v85, v3, 0x41980000, v78
    v_cos_f32 v86, v78
    v_cos_f32 v87, v79
    v_cos_f32 v88, v80
    v_cos_f32 v89, v81
    v_cos_f32 v90, v82
    v_cos_f32 v91, v83
    v_cos_f32 v92, v84
    v_cos_f32 v93, v85
    v_sin_f32 v78, v78
PADF35:
    s_cbranch_execz RETF
    v_sin_f32 v79, v79
    v_sin_f32 v80, v80
    v_sin_f32 v81, v81
    v_sin_f32 v82, v82
    v_sin_f32 v83, v83
    v_sin_f32 v84, v84
    v_sin_f32 v85, v85
    v_lshlrev_b32 v94, 31, v1
    v_or_b32 v94, 1.0, v94
    v_cmp_gt_u32 vcc, 16, v1
    s_nop 1
    v_cndmask_b32 v78, v78, v94, vcc
    v_cvt_pk_bf16_f32 v246, v86, v78
    v_cvt_pk_bf16_f32 v247, v87, v79
PADF36:
    s_cbranch_execz PADF37
    v_cvt_pk_bf16_f32 v248, v88, v80
    v_cvt_pk_bf16_f32 v249, v89, v81
    v_cvt_pk_bf16_f32 v250, v90, v82
    v_cvt_pk_bf16_f32 v251, v91, v83
    v_cvt_pk_bf16_f32 v252, v92, v84
    v_cvt_pk_bf16_f32 v253, v93, v85
    v_bfe_u32 v3, v1, 2, 2
PADF37:
    s_cbranch_execz PADF38
    s_and_b32 s54, s3, 1
    v_xor_b32 v3, s54, v3
    s_lshl_b32 s54, s35, 2
    v_add_u32 v3, s54, v3
    v_subrev_u32 v94, 14, v3
    v_min_u32 v3, v3, v94
    v_lshlrev_b32 v3, 6, v3
    v_sub_u32 v94, 1344, v3
    v_cmp_gt_u32 vcc, 448, v3
    s_nop 1
    v_cndmask_b32 v3, v94, v3, vcc
    v_lshl_add_u32 v3, v5, 10, v3
PADF38:
    s_cbranch_execz PADF39
    v_and_b32 v94, 3, v1
    v_lshl_add_u32 v12, v94, 4, v3
    buffer_load_dwordx2 v[14:15], v11, s[4:7], s63 offen offset:0
    buffer_load_dwordx2 v[16:17], v11, s[4:7], s63 offen offset:32
    s_waitcnt vmcnt(7)
    v_mfma_f32_16x16x32_bf16 v[134:137], v[166:169], v[22:25], 0
    s_waitcnt vmcnt(6)
    v_mfma_f32_16x16x32_bf16 v[150:153], v[166:169], v[26:29], 0
    ds_read_b64_tr_b16 v[166:167], v18 offset:49152
PADF39:
    s_cbranch_execz PADF40
    ds_read_b64_tr_b16 v[168:169], v18 offset:51200
    s_lshl_b32 s49, s92, 5
    s_add_u32 s49, s49, s59
    buffer_load_dwordx4 v[46:49], v6, s[16:19], s49 offen sc1
    buffer_load_dwordx4 v[50:53], v7, s[16:19], s49 offen sc1
    v_mfma_f32_16x16x32_bf16 v[138:141], v[170:173], v[22:25], 0
    v_mfma_f32_16x16x32_bf16 v[154:157], v[170:173], v[26:29], 0
    ds_read_b64_tr_b16 v[170:171], v19 offset:49152
    ds_read_b64_tr_b16 v[172:173], v19 offset:51200
PADF40:
    s_cbranch_execz PADF41
    v_mfma_f32_16x16x32_bf16 v[142:145], v[174:177], v[22:25], 0
    v_mfma_f32_16x16x32_bf16 v[158:161], v[174:177], v[26:29], 0
    ds_read_b64_tr_b16 v[174:175], v20 offset:49152
    ds_read_b64_tr_b16 v[176:177], v20 offset:51200
    v_mfma_f32_16x16x32_bf16 v[146:149], v[178:181], v[22:25], 0
    v_mfma_f32_16x16x32_bf16 v[162:165], v[178:181], v[26:29], 0
    ds_read_b64_tr_b16 v[178:179], v21 offset:49152
PADF41:
    s_cbranch_execz PADF42
    ds_read_b64_tr_b16 v[180:181], v21 offset:51200
    s_waitcnt vmcnt(7)
    v_mfma_f32_16x16x32_bf16 v[134:137], v[182:185], v[30:33], v[134:137]
    s_waitcnt vmcnt(6)
    v_mfma_f32_16x16x32_bf16 v[150:153], v[182:185], v[34:37], v[150:153]
    ds_read_b64_tr_b16 v[182:183], v18 offset:0
    ds_read_b64_tr_b16 v[184:185], v18 offset:2048
    s_mov_b32 exec_hi, 0
    buffer_load_dword v10, v8, s[16:19], s61 offen offset:256 sc1
PADF42:
    s_cbranch_execz PADF43
    s_mov_b32 exec_hi, -1
    s_lshl_b32 s49, s93, 5
    s_add_u32 s49, s49, s59
    buffer_load_dwordx4 v[54:57], v6, s[16:19], s49 offen sc1
    buffer_load_dwordx4 v[58:61], v7, s[16:19], s49 offen sc1
    v_mfma_f32_16x16x32_bf16 v[138:141], v[186:189], v[30:33], v[138:141]
    v_mfma_f32_16x16x32_bf16 v[154:157], v[186:189], v[34:37], v[154:157]
    ds_read_b64_tr_b16 v[186:187], v19 offset:0
    ds_read_b64_tr_b16 v[188:189], v19 offset:2048
PADF43:
    s_cbranch_execz PADF44
    v_mfma_f32_16x16x32_bf16 v[142:145], v[190:193], v[30:33], v[142:145]
    v_mfma_f32_16x16x32_bf16 v[158:161], v[190:193], v[34:37], v[158:161]
    ds_read_b64_tr_b16 v[190:191], v20 offset:0
    ds_read_b64_tr_b16 v[192:193], v20 offset:2048
    v_mfma_f32_16x16x32_bf16 v[146:149], v[194:197], v[30:33], v[146:149]
    v_mfma_f32_16x16x32_bf16 v[162:165], v[194:197], v[34:37], v[162:165]
    ds_read_b64_tr_b16 v[194:195], v21 offset:0
    ds_read_b64_tr_b16 v[196:197], v21 offset:2048
PADF44:
    s_cbranch_execz PADF45
    v_add_u32 v18, 0xffffc000, v18
    v_add_u32 v19, 0xffffc000, v19
    v_add_u32 v20, 0xffffc000, v20
    v_add_u32 v21, 0xffffc000, v21
    s_waitcnt vmcnt(8)
    v_mfma_f32_16x16x32_bf16 v[134:137], v[198:201], v[38:41], v[134:137]
    s_waitcnt vmcnt(7)
    v_mfma_f32_16x16x32_bf16 v[150:153], v[198:201], v[42:45], v[150:153]
PADF45:
    s_cbranch_execz PADF46
    ds_read_b64_tr_b16 v[198:199], v18 offset:0
    ds_read_b64_tr_b16 v[200:201], v18 offset:2048
    s_lshl_b32 s49, s94, 5
    s_add_u32 s49, s49, s59
    buffer_load_dwordx4 v[62:65], v6, s[16:19], s49 offen sc1
    buffer_load_dwordx4 v[66:69], v7, s[16:19], s49 offen sc1
    v_mfma_f32_16x16x32_bf16 v[138:141], v[202:205], v[38:41], v[138:141]
    v_mfma_f32_16x16x32_bf16 v[154:157], v[202:205], v[42:45], v[154:157]
    ds_read_b64_tr_b16 v[202:203], v19 offset:0
PADF46:
    s_cbranch_execz PADF47
    ds_read_b64_tr_b16 v[204:205], v19 offset:2048
    v_mfma_f32_16x16x32_bf16 v[142:145], v[206:209], v[38:41], v[142:145]
    v_mfma_f32_16x16x32_bf16 v[158:161], v[206:209], v[42:45], v[158:161]
    ds_read_b64_tr_b16 v[206:207], v20 offset:0
    ds_read_b64_tr_b16 v[208:209], v20 offset:2048
    v_mfma_f32_16x16x32_bf16 v[146:149], v[210:213], v[38:41], v[146:149]
    v_mfma_f32_16x16x32_bf16 v[162:165], v[210:213], v[42:45], v[162:165]
PADF47:
    s_cbranch_execz RETF
    ds_read_b64_tr_b16 v[210:211], v21 offset:0
    ds_read_b64_tr_b16 v[212:213], v21 offset:2048
    s_waitcnt vmcnt(6)
    v_mfma_f32_16x16x32_bf16 v[134:137], v[214:217], v[46:49], v[134:137]
    s_waitcnt vmcnt(5)
    v_mfma_f32_16x16x32_bf16 v[150:153], v[214:217], v[50:53], v[150:153]
    ds_read_b64_tr_b16 v[214:215], v18 offset:32768
    ds_read_b64_tr_b16 v[216:217], v18 offset:34816
    s_lshl_b32 s49, s95, 5
PADF48:
    s_cbranch_execz PADF49
    s_add_u32 s49, s49, s59
    buffer_load_dwordx4 v[70:73], v6, s[16:19], s49 offen sc1
    buffer_load_dwordx4 v[74:77], v7, s[16:19], s49 offen sc1
    v_mfma_f32_16x16x32_bf16 v[138:141], v[218:221], v[46:49], v[138:141]
    v_mfma_f32_16x16x32_bf16 v[154:157], v[218:221], v[50:53], v[154:157]
    ds_read_b64_tr_b16 v[218:219], v19 offset:32768
    ds_read_b64_tr_b16 v[220:221], v19 offset:34816
    v_mfma_f32_16x16x32_bf16 v[142:145], v[222:225], v[46:49], v[142:145]
PADF49:
    s_cbranch_execz PADF50
    v_mfma_f32_16x16x32_bf16 v[158:161], v[222:225], v[50:53], v[158:161]
    ds_read_b64_tr_b16 v[222:223], v20 offset:32768
    ds_read_b64_tr_b16 v[224:225], v20 offset:34816
    v_mfma_f32_16x16x32_bf16 v[146:149], v[226:229], v[46:49], v[146:149]
    v_mfma_f32_16x16x32_bf16 v[162:165], v[226:229], v[50:53], v[162:165]
    ds_read_b64_tr_b16 v[226:227], v21 offset:32768
    ds_read_b64_tr_b16 v[228:229], v21 offset:34816
    s_waitcnt vmcnt(5)
PADF50:
    s_cbranch_execz PADF51
    v_mfma_f32_16x16x32_bf16 v[134:137], v[230:233], v[54:57], v[134:137]
    s_waitcnt vmcnt(4)
    v_mfma_f32_16x16x32_bf16 v[150:153], v[230:233], v[58:61], v[150:153]
    ds_read_b64_tr_b16 v[230:231], v18 offset:49152
    ds_read_b64_tr_b16 v[232:233], v18 offset:51200
    v_cmp_eq_u32 vcc, 1, v10
    s_nop 0
    s_andn2_b32 s54, s36, vcc_lo
    s_cbranch_scc0 SP3_D
    s_mov_b32 s99, 0
    s_mov_b32 exec_hi, 0
SP3:
PADF51:
    s_cbranch_execz PADF52
    buffer_load_dword v10, v8, s[16:19], s61 offen offset:256 sc1
    s_add_u32 s99, s99, 1
    s_waitcnt vmcnt(0)
    v_cmp_eq_u32 vcc, 1, v10
    s_nop 1
    s_or_b32 s54, vcc_lo, vcc_hi
    s_andn2_b32 s54, s36, s54
    s_cbranch_scc0 SP3_E
    s_cmp_lg_u32 s99, 24
    s_cbranch_scc1 SP3_C
    s_mov_b32 exec_lo, 1
    buffer_store_dword v13, off, s[16:19], s60 offset:128 sc1
    s_mov_b64 exec, -1
SP3_C:
PADF52:
    s_cbranch_execz PADF53
    s_cmp_lt_u32 s99, 131072
    s_cbranch_scc1 SP3
SP3_E:
    s_mov_b64 exec, -1
SP3_D:
    v_and_b32 v8, 3, v1
    v_lshlrev_b32 v8, 13, v8
    s_lshl_b32 s49, s89, 5
    s_mul_i32 s64, s65, 114688
    s_add_u32 s59, s59, s64
    s_add_u32 s49, s49, s59
    buffer_load_dwordx4 v[78:81], v6, s[16:19], s49 offen sc1
    buffer_load_dwordx4 v[82:85], v7, s[16:19], s49 offen sc1
PADF53:
    s_cbranch_execz PADF54
    v_mfma_f32_16x16x32_bf16 v[138:141], v[234:237], v[54:57], v[138:141]
    v_mfma_f32_16x16x32_bf16 v[154:157], v[234:237], v[58:61], v[154:157]
    ds_read_b64_tr_b16 v[234:235], v19 offset:49152
    ds_read_b64_tr_b16 v[236:237], v19 offset:51200
    v_mfma_f32_16x16x32_bf16 v[142:145], v[238:241], v[54:57], v[142:145]
    v_mfma_f32_16x16x32_bf16 v[158:161], v[238:241], v[58:61], v[158:161]
    ds_read_b64_tr_b16 v[238:239], v20 offset:49152
    ds_read_b64_tr_b16 v[240:241], v20 offset:51200
PADF54:
    s_cbranch_execz PADF55
    v_mfma_f32_16x16x32_bf16 v[146:149], v[242:245], v[54:57], v[146:149]
    v_mfma_f32_16x16x32_bf16 v[162:165], v[242:245], v[58:61], v[162:165]
    ds_read_b64_tr_b16 v[242:243], v21 offset:49152
    ds_read_b64_tr_b16 v[244:245], v21 offset:51200
    v_add_u32 v18, 0xffff0000, v18
    v_add_u32 v19, 0xffff0000, v19
    v_add_u32 v20, 0xffff0000, v20
PADF55:
    s_cbranch_execz PADF56
    v_add_u32 v21, 0xffff0000, v21
    s_waitcnt vmcnt(5) lgkmcnt(15)
    v_mfma_f32_16x16x32_bf16 v[134:137], v[166:169], v[62:65], v[134:137]
    s_waitcnt vmcnt(4)
    v_mfma_f32_16x16x32_bf16 v[150:153], v[166:169], v[66:69], v[150:153]
    ds_read_b64_tr_b16 v[166:167], v18 offset:0
    ds_read_b64_tr_b16 v[168:169], v18 offset:2048
    s_lshl_b32 s49, s90, 5
    s_add_u32 s49, s49, s59
    buffer_load_dwordx4 v[86:89], v6, s[16:19], s49 offen sc1
PADF56:
    s_cbranch_execz PADF57
    buffer_load_dwordx4 v[90:93], v7, s[16:19], s49 offen sc1
    v_mfma_f32_16x16x32_bf16 v[138:141], v[170:173], v[62:65], v[138:141]
    v_mfma_f32_16x16x32_bf16 v[154:157], v[170:173], v[66:69], v[154:157]
    ds_read_b64_tr_b16 v[170:171], v19 offset:0
    ds_read_b64_tr_b16 v[172:173], v19 offset:2048
    v_mfma_f32_16x16x32_bf16 v[142:145], v[174:177], v[62:65], v[142:145]
    v_mfma_f32_16x16x32_bf16 v[158:161], v[174:177], v[66:69], v[158:161]
PADF57:
    s_cbranch_execz PADF58
    ds_read_b64_tr_b16 v[174:175], v20 offset:0
    ds_read_b64_tr_b16 v[176:177], v20 offset:2048
    v_mfma_f32_16x16x32_bf16 v[146:149], v[178:181], v[62:65], v[146:149]
    v_mfma_f32_16x16x32_bf16 v[162:165], v[178:181], v[66:69], v[162:165]
    ds_read_b64_tr_b16 v[178:179], v21 offset:0
    ds_read_b64_tr_b16 v[180:181], v21 offset:2048
    s_waitcnt vmcnt(5)
    v_mfma_f32_16x16x32_bf16 v[134:137], v[182:185], v[70:73], v[134:137]
PADF58:
    s_cbranch_execz PADF59
    s_waitcnt vmcnt(4)
    v_mfma_f32_16x16x32_bf16 v[150:153], v[182:185], v[74:77], v[150:153]
    ds_read_b64_tr_b16 v[182:183], v18 offset:16384
    ds_read_b64_tr_b16 v[184:185], v18 offset:18432
    s_lshl_b32 s49, s91, 5
    s_add_u32 s49, s49, s59
    buffer_load_dwordx4 v[94:97], v6, s[16:19], s49 offen sc1
    buffer_load_dwordx4 v[98:101], v7, s[16:19], s49 offen sc1
    v_mfma_f32_16x16x32_bf16 v[138:141], v[186:189], v[70:73], v[138:141]
PADF59:
    s_cbranch_execz RETF
    v_mfma_f32_16x16x32_bf16 v[154:157], v[186:189], v[74:77], v[154:157]
    ds_read_b64_tr_b16 v[186:187], v19 offset:16384
    ds_read_b64_tr_b16 v[188:189], v19 offset:18432
    v_mfma_f32_16x16x32_bf16 v[142:145], v[190:193], v[70:73], v[142:145]
    v_mfma_f32_16x16x32_bf16 v[158:161], v[190:193], v[74:77], v[158:161]
    ds_read_b64_tr_b16 v[190:191], v20 offset:16384
    ds_read_b64_tr_b16 v[192:193], v20 offset:18432
    v_mfma_f32_16x16x32_bf16 v[146:149], v[194:197], v[70:73], v[146:149]
PADF60:
    s_cbranch_execz PADF61
    v_mfma_f32_16x16x32_bf16 v[162:165], v[194:197], v[74:77], v[162:165]
    ds_read_b64_tr_b16 v[194:195], v21 offset:16384
    ds_read_b64_tr_b16 v[196:197], v21 offset:18432
    s_waitcnt vmcnt(5)
    v_mfma_f32_16x16x32_bf16 v[134:137], v[198:201], v[78:81], v[134:137]
    s_waitcnt vmcnt(4)
    v_mfma_f32_16x16x32_bf16 v[150:153], v[198:201], v[82:85], v[150:153]
    ds_read_b64_tr_b16 v[198:199], v18 offset:32768
PADF61:
    s_cbranch_execz PADF62
    ds_read_b64_tr_b16 v[200:201], v18 offset:34816
    s_lshl_b32 s49, s92, 5
    s_add_u32 s49, s49, s59
    buffer_load_dwordx4 v[102:105], v6, s[16:19], s49 offen sc1
    buffer_load_dwordx4 v[106:109], v7, s[16:19], s49 offen sc1
    v_mfma_f32_16x16x32_bf16 v[138:141], v[202:205], v[78:81], v[138:141]
    v_mfma_f32_16x16x32_bf16 v[154:157], v[202:205], v[82:85], v[154:157]
    ds_read_b64_tr_b16 v[202:203], v19 offset:32768
    ds_read_b64_tr_b16 v[204:205], v19 offset:34816
PADF62:
    s_cbranch_execz PADF63
    v_mfma_f32_16x16x32_bf16 v[142:145], v[206:209], v[78:81], v[142:145]
    v_mfma_f32_16x16x32_bf16 v[158:161], v[206:209], v[82:85], v[158:161]
    ds_read_b64_tr_b16 v[206:207], v20 offset:32768
    ds_read_b64_tr_b16 v[208:209], v20 offset:34816
    v_mfma_f32_16x16x32_bf16 v[146:149], v[210:213], v[78:81], v[146:149]
    v_mfma_f32_16x16x32_bf16 v[162:165], v[210:213], v[82:85], v[162:165]
    ds_read_b64_tr_b16 v[210:211], v21 offset:32768
PADF63:
    s_cbranch_execz PADF64
    ds_read_b64_tr_b16 v[212:213], v21 offset:34816
    s_waitcnt vmcnt(5) lgkmcnt(15)
    v_mfma_f32_16x16x32_bf16 v[134:137], v[214:217], v[86:89], v[134:137]
    s_waitcnt vmcnt(4)
    v_mfma_f32_16x16x32_bf16 v[150:153], v[214:217], v[90:93], v[150:153]
    ds_read_b64_tr_b16 v[214:215], v18 offset:49152
    ds_read_b64_tr_b16 v[216:217], v18 offset:51200
    s_lshl_b32 s49, s93, 5
    s_add_u32 s49, s49, s59
    buffer_load_dwordx4 v[110:113], v6, s[16:19], s49 offen sc1
PADF64:
    s_cbranch_execz PADF65
    buffer_load_dwordx4 v[114:117], v7, s[16:19], s49 offen sc1
    v_mfma_f32_16x16x32_bf16 v[138:141], v[218:221], v[86:89], v[138:141]
    v_mfma_f32_16x16x32_bf16 v[154:157], v[218:221], v[90:93], v[154:157]
    ds_read_b64_tr_b16 v[218:219], v19 offset:49152
    ds_read_b64_tr_b16 v[220:221], v19 offset:51200
    v_mfma_f32_16x16x32_bf16 v[142:145], v[222:225], v[86:89], v[142:145]
    v_mfma_f32_16x16x32_bf16 v[158:161], v[222:225], v[90:93], v[158:161]
PADF65:
    s_cbranch_execz PADF66
    ds_read_b64_tr_b16 v[222:223], v20 offset:49152
    ds_read_b64_tr_b16 v[224:225], v20 offset:51200
    v_mfma_f32_16x16x32_bf16 v[146:149], v[226:229], v[86:89], v[146:149]
    v_mfma_f32_16x16x32_bf16 v[162:165], v[226:229], v[90:93], v[162:165]
    ds_read_b64_tr_b16 v[226:227], v21 offset:49152
    ds_read_b64_tr_b16 v[228:229], v21 offset:51200
    s_waitcnt vmcnt(5)
    v_mfma_f32_16x16x32_bf16 v[134:137], v[230:233], v[94:97], v[134:137]
PADF66:
    s_cbranch_execz PADF67
    s_and_b32 s0, s38, 2
    s_add_u32 s0, s0, 0
    s_lshl_b32 s54, s35, 2
    s_add_u32 s54, s54, s0
    s_waitcnt vmcnt(4)
    v_mfma_f32_16x16x32_bf16 v[150:153], v[230:233], v[98:101], v[150:153]
    s_cmp_ge_u32 s54, 14
    s_cselect_b32 s64, 14, 0
    s_cselect_b32 s65, 0x80008000, 0
    s_sub_u32 s54, s54, s64
    s_lshl_b32 s49, s94, 5
    s_add_u32 s49, s49, s59
    buffer_load_dwordx4 v[118:121], v6, s[16:19], s49 offen sc1
PADF67:
    s_cbranch_execz PADF68
    buffer_load_dwordx4 v[122:125], v7, s[16:19], s49 offen sc1
    v_mfma_f32_16x16x32_bf16 v[138:141], v[234:237], v[94:97], v[138:141]
    s_cmp_ge_u32 s54, 7
    s_cselect_b32 s64, 15, 0
    s_cselect_b32 s54, 0x80008000, 0
    s_xor_b32 s65, s65, s54
    v_mfma_f32_16x16x32_bf16 v[154:157], v[234:237], v[98:101], v[154:157]
    v_and_b32 v4, 1, v5
    v_mfma_f32_16x16x32_bf16 v[142:145], v[238:241], v[94:97], v[142:145]
PADF68:
    s_cbranch_execz PADF69
    v_xor_b32 v4, s0, v4
    v_mfma_f32_16x16x32_bf16 v[158:161], v[238:241], v[98:101], v[158:161]
    v_lshlrev_b32 v4, 6, v4
    v_mfma_f32_16x16x32_bf16 v[146:149], v[242:245], v[94:97], v[146:149]
    v_lshl_add_u32 v4, v5, 11, v4
    v_mfma_f32_16x16x32_bf16 v[162:165], v[242:245], v[98:101], v[162:165]
    v_and_b32 v18, 15, v1
    s_waitcnt vmcnt(5)
    v_mfma_f32_16x16x32_bf16 v[134:137], v[166:169], v[102:105], v[134:137]
    v_xor_b32 v18, s64, v18
PADF69:
    s_cbranch_execz PADF70
    s_waitcnt vmcnt(4)
    v_mfma_f32_16x16x32_bf16 v[150:153], v[166:169], v[106:109], v[150:153]
    v_lshl_add_u32 v18, v18, 2, v4
    s_lshl_b32 s49, s95, 5
    s_add_u32 s49, s49, s59
    buffer_load_dwordx4 v[126:129], v6, s[16:19], s49 offen sc1
    buffer_load_dwordx4 v[130:133], v7, s[16:19], s49 offen sc1
    buffer_load_dword v10, v8, s[16:19], s62 offen sc1
    s_mov_b64 exec, 1
    buffer_store_dword v13, off, s[16:19], s60 offset:128 sc1
PADF70:
    s_cbranch_execz PADF71
    s_mov_b64 exec, -1
    v_mfma_f32_16x16x32_bf16 v[138:141], v[170:173], v[102:105], v[138:141]
    v_xor_b32 v62, s65, v246
    v_mfma_f32_16x16x32_bf16 v[154:157], v[170:173], v[106:109], v[154:157]
    v_xor_b32 v63, s65, v247
    v_mfma_f32_16x16x32_bf16 v[142:145], v[174:177], v[102:105], v[142:145]
    v_xor_b32 v64, s65, v248
    v_mfma_f32_16x16x32_bf16 v[158:161], v[174:177], v[106:109], v[158:161]
    v_xor_b32 v65, s65, v249
    v_mfma_f32_16x16x32_bf16 v[146:149], v[178:181], v[102:105], v[146:149]
PADF71:
    s_cbranch_execz RETF
    v_xor_b32 v66, s65, v250
    v_mfma_f32_16x16x32_bf16 v[162:165], v[178:181], v[106:109], v[162:165]
    v_xor_b32 v67, s65, v251
    v_xor_b32 v68, s65, v252
    s_waitcnt vmcnt(7) lgkmcnt(15)
    v_mfma_f32_16x16x32_bf16 v[134:137], v[182:185], v[110:113], v[134:137]
    v_xor_b32 v69, s65, v253
    s_waitcnt vmcnt(6)
    v_mfma_f32_16x16x32_bf16 v[150:153], v[182:185], v[114:117], v[150:153]
    s_and_b32 s0, s38, 2
    s_add_u32 s0, s0, 1
PADF72:
    s_cbranch_execz PADF73
    s_lshl_b32 s54, s35, 2
    s_add_u32 s54, s54, s0
    v_mfma_f32_16x16x32_bf16 v[138:141], v[186:189], v[110:113], v[138:141]
    s_cmp_ge_u32 s54, 14
    s_cselect_b32 s64, 14, 0
    s_cselect_b32 s65, 0x80008000, 0
    s_sub_u32 s54, s54, s64
    v_mfma_f32_16x16x32_bf16 v[154:157], v[186:189], v[114:117], v[154:157]
    s_cmp_ge_u32 s54, 7
    s_cselect_b32 s64, 15, 0
    s_cselect_b32 s54, 0x80008000, 0
PADF73:
    s_cbranch_execz PADF74
    s_xor_b32 s65, s65, s54
    v_mfma_f32_16x16x32_bf16 v[142:145], v[190:193], v[110:113], v[142:145]
    v_and_b32 v4, 1, v5
    v_mfma_f32_16x16x32_bf16 v[158:161], v[190:193], v[114:117], v[158:161]
    v_xor_b32 v4, s0, v4
    v_mfma_f32_16x16x32_bf16 v[146:149], v[194:197], v[110:113], v[146:149]
    v_lshlrev_b32 v4, 6, v4
    v_mfma_f32_16x16x32_bf16 v[162:165], v[194:197], v[114:117], v[162:165]
    v_lshl_add_u32 v4, v5, 11, v4
    v_and_b32 v19, 15, v1
PADF74:
    s_cbranch_execz PADF75
    s_waitcnt lgkmcnt(0)
    s_barrier
    s_waitcnt vmcnt(5)
    v_mfma_f32_16x16x32_bf16 v[134:137], v[198:201], v[118:121], v[134:137]
    v_xor_b32 v19, s64, v19
    s_waitcnt vmcnt(4)
    v_mfma_f32_16x16x32_bf16 v[150:153], v[198:201], v[122:125], v[150:153]
    v_lshl_add_u32 v19, v19, 2, v4
    v_mfma_f32_16x16x32_bf16 v[138:141], v[202:205], v[118:121], v[138:141]
    v_xor_b32 v70, s65, v246
    v_mfma_f32_16x16x32_bf16 v[154:157], v[202:205], v[122:125], v[154:157]
PADF75:
    s_cbranch_execz PADF76
    v_xor_b32 v71, s65, v247
    v_mfma_f32_16x16x32_bf16 v[142:145], v[206:209], v[118:121], v[142:145]
    v_xor_b32 v72, s65, v248
    v_mfma_f32_16x16x32_bf16 v[158:161], v[206:209], v[122:125], v[158:161]
    v_xor_b32 v73, s65, v249
    v_mfma_f32_16x16x32_bf16 v[146:149], v[210:213], v[118:121], v[146:149]
    v_xor_b32 v74, s65, v250
    v_mfma_f32_16x16x32_bf16 v[162:165], v[210:213], v[122:125], v[162:165]
    v_xor_b32 v75, s65, v251
    v_xor_b32 v76, s65, v252
PADF76:
    s_cbranch_execz PADF77
    s_waitcnt vmcnt(3)
    v_mfma_f32_16x16x32_bf16 v[134:137], v[214:217], v[126:129], v[134:137]
    v_xor_b32 v77, s65, v253
    s_waitcnt vmcnt(2)
    v_mfma_f32_16x16x32_bf16 v[150:153], v[214:217], v[130:133], v[150:153]
    s_xor_b32 s54, s3, 1
    s_mul_i32 s54, s54, 6144
    s_add_u32 s54, s54, 81920
    v_mfma_f32_16x16x32_bf16 v[138:141], v[218:221], v[126:129], v[138:141]
    v_add_u32 v20, s54, v2
PADF77:
    s_cbranch_execz PADF78
    v_mfma_f32_16x16x32_bf16 v[154:157], v[218:221], v[130:133], v[154:157]
    s_xor_b32 s54, s3, 2
    s_mul_i32 s54, s54, 6144
    s_add_u32 s54, s54, 81920
    v_mfma_f32_16x16x32_bf16 v[142:145], v[222:225], v[126:129], v[142:145]
    v_add_u32 v21, s54, v2
    v_mfma_f32_16x16x32_bf16 v[158:161], v[222:225], v[130:133], v[158:161]
    s_xor_b32 s54, s3, 3
    s_mul_i32 s54, s54, 6144
PADF78:
    s_cbranch_execz PADF79
    s_add_u32 s54, s54, 81920
    v_mfma_f32_16x16x32_bf16 v[146:149], v[226:229], v[126:129], v[146:149]
    v_add_u32 v9, s54, v2
    v_mfma_f32_16x16x32_bf16 v[162:165], v[226:229], v[130:133], v[162:165]
    s_xor_b32 s54, s3, 0
    s_mul_i32 s54, s54, 6144
    s_add_u32 s54, s54, 81920
    v_add_u32 v3, s54, v2
    s_waitcnt vmcnt(1)
    v_cmp_ne_u32 vcc, 1, v10
PADF79:
    s_cbranch_execz PADF80
    s_nop 0
    s_and_b32 s98, vcc_lo, 15
    s_cbranch_scc1 V2LATE
    s_lshl_b32 m0, s3, 11
    s_nop 0
    buffer_load_dwordx4 v12, s[16:19], s32 offen sc1 lds
    buffer_load_dwordx4 v12, s[16:19], s47 offen offset:1024 sc1 lds
    s_branch V2L2
V2LATE:
    buffer_load_dword v10, v8, s[16:19], s62 offen sc1
V2L2:
    ds_write_b128 v20, v[150:153] offset:0
    ds_write_b128 v20, v[154:157] offset:1024
PADF80:
    s_cbranch_execz PADF81
    ds_write_b128 v21, v[142:145] offset:2048
    ds_write_b128 v21, v[146:149] offset:3072
    ds_write_b128 v9, v[158:161] offset:4096
    ds_write_b128 v9, v[162:165] offset:5120
    v_lshlrev_b32 v54, 16, v14
    v_and_b32 v55, 0xffff0000, v14
    v_lshlrev_b32 v56, 16, v15
    v_and_b32 v57, 0xffff0000, v15
PADF81:
    s_cbranch_execz PADF82
    v_lshlrev_b32 v58, 16, v16
    v_and_b32 v59, 0xffff0000, v16
    v_lshlrev_b32 v60, 16, v17
    v_and_b32 v61, 0xffff0000, v17
    v_mov_b32 v4, 0x48e00000
    v_mov_b32 v5, 0xbfb8aa3b
    s_waitcnt lgkmcnt(0)
    s_barrier
    ds_read_b128 v[22:25], v3 offset:0
    ds_read_b128 v[26:29], v3 offset:1024
PADF82:
    s_cbranch_execz PADF83
    ds_read_b128 v[30:33], v3 offset:2048
    ds_read_b128 v[34:37], v3 offset:3072
    ds_read_b128 v[38:41], v3 offset:4096
    ds_read_b128 v[42:45], v3 offset:5120
    s_cmp_eq_u32 s98, 0
    s_cbranch_scc1 V2M0
    s_waitcnt vmcnt(0)
    v_cmp_ne_u32 vcc, 1, v10
    s_nop 0
    s_and_b32 s98, vcc_lo, 15
PADF83:
    s_cbranch_execz RETF
    s_cbranch_scc1 V2N0
    s_lshl_b32 m0, s3, 11
    s_nop 0
    buffer_load_dwordx4 v12, s[16:19], s32 offen sc1 lds
    buffer_load_dwordx4 v12, s[16:19], s47 offen offset:1024 sc1 lds
    s_branch V2M0
V2N0:
    buffer_load_dword v10, v8, s[16:19], s62 offen sc1
V2M0:
    s_waitcnt lgkmcnt(5)
    v_pk_add_f32 v[134:135], v[134:135], v[22:23]
    v_pk_add_f32 v[136:137], v[136:137], v[24:25]
PADF84:
    s_cbranch_execz PADF85
    s_waitcnt lgkmcnt(4)
    v_pk_add_f32 v[138:139], v[138:139], v[26:27]
    v_pk_add_f32 v[140:141], v[140:141], v[28:29]
    s_waitcnt lgkmcnt(1)
    v_pk_add_f32 v[30:31], v[30:31], v[38:39]
    v_pk_add_f32 v[32:33], v[32:33], v[40:41]
    s_waitcnt lgkmcnt(0)
    v_pk_add_f32 v[34:35], v[34:35], v[42:43]
    v_pk_add_f32 v[36:37], v[36:37], v[44:45]
PADF85:
    s_cbranch_execz PADF86
    v_pk_add_f32 v[134:135], v[134:135], v[30:31]
    v_pk_add_f32 v[136:137], v[136:137], v[32:33]
    v_pk_add_f32 v[138:139], v[138:139], v[34:35]
    v_pk_add_f32 v[140:141], v[140:141], v[36:37]
    v_pk_mul_f32 v[46:47], v[134:135], v[4:5] op_sel:[0,1]
    v_pk_mul_f32 v[48:49], v[136:137], v[4:5] op_sel:[0,1]
    v_pk_mul_f32 v[50:51], v[138:139], v[4:5] op_sel:[0,1]
    v_pk_mul_f32 v[52:53], v[140:141], v[4:5] op_sel:[0,1]
PADF86:
    s_cbranch_execz PADF87
    v_exp_f32 v46, v46
    v_exp_f32 v47, v47
    v_exp_f32 v48, v48
    v_exp_f32 v49, v49
    v_exp_f32 v50, v50
    v_exp_f32 v51, v51
    v_exp_f32 v52, v52
    v_exp_f32 v53, v53
    v_pk_fma_f32 v[46:47], v[46:47], v[4:5], v[4:5] op_sel_hi:[1,0,0]
    v_pk_fma_f32 v[48:49], v[48:49], v[4:5], v[4:5] op_sel_hi:[1,0,0]
    v_pk_fma_f32 v[50:51], v[50:51], v[4:5], v[4:5] op_sel_hi:[1,0,0]
PADF87:
    s_cbranch_execz PADF88
    v_pk_fma_f32 v[52:53], v[52:53], v[4:5], v[4:5] op_sel_hi:[1,0,0]
    v_rcp_f32 v46, v46
    v_rcp_f32 v47, v47
    v_rcp_f32 v48, v48
    v_rcp_f32 v49, v49
    v_rcp_f32 v50, v50
    v_rcp_f32 v51, v51
    v_rcp_f32 v52, v52
    v_rcp_f32 v53, v53
    v_pk_mul_f32 v[134:135], v[134:135], v[46:47]
    v_pk_mul_f32 v[136:137], v[136:137], v[48:49]
    v_pk_mul_f32 v[138:139], v[138:139], v[50:51]
PADF88:
    s_cbranch_execz PADF89
    v_pk_mul_f32 v[140:141], v[140:141], v[52:53]
    s_cmp_eq_u32 s98, 0
    s_cbranch_scc1 V2OK
    s_waitcnt vmcnt(0)
    s_mov_b32 s99, 0
    v_cmp_ne_u32 vcc, 1, v10
    s_nop 0
    s_and_b64 vcc, vcc, 0xf
    s_cbranch_scc0 SP4_D
    s_mov_b64 exec, 0xf
SP4:
    buffer_load_dword v10, v8, s[16:19], s62 offen sc1
    s_add_u32 s99, s99, 1
PADF89:
    s_cbranch_execz PADF90
    s_waitcnt vmcnt(0)
    v_cmp_ne_u32 vcc, 1, v10
    s_nop 1
    s_cmp_eq_u64 vcc, 0
    s_cbranch_scc1 SP4_E
    s_cmp_lt_u32 s99, 131072
    s_cbranch_scc1 SP4
SP4_E:
    s_mov_b64 exec, -1
SP4_D:
    s_lshl_b32 m0, s3, 11
    s_nop 0
    buffer_load_dwordx4 v12, s[16:19], s32 offen sc1 lds
    buffer_load_dwordx4 v12, s[16:19], s47 offen offset:1024 sc1 lds
V2OK:
PADF90:
    s_cbranch_execz PADF91
    s_waitcnt vmcnt(0)
    s_barrier
    ds_read2st64_b32 v[78:79], v18 offset0:0 offset1:2
    ds_read2st64_b32 v[80:81], v18 offset0:4 offset1:6
    ds_read2st64_b32 v[82:83], v18 offset0:32 offset1:34
    ds_read2st64_b32 v[84:85], v18 offset0:36 offset1:38
    ds_read2st64_b32 v[86:87], v18 offset0:1 offset1:3
    ds_read2st64_b32 v[88:89], v18 offset0:5 offset1:7
    ds_read2st64_b32 v[90:91], v18 offset0:33 offset1:35
PADF91:
    s_cbranch_execz PADF92
    ds_read2st64_b32 v[92:93], v18 offset0:37 offset1:39
    ds_read2st64_b32 v[94:95], v19 offset0:0 offset1:2
    ds_read2st64_b32 v[96:97], v19 offset0:4 offset1:6
    ds_read2st64_b32 v[98:99], v19 offset0:32 offset1:34
    ds_read2st64_b32 v[100:101], v19 offset0:36 offset1:38
    ds_read2st64_b32 v[102:103], v19 offset0:1 offset1:3
    ds_read2st64_b32 v[104:105], v19 offset0:5 offset1:7
PADF92:
    s_cbranch_execz PADF93
    ds_read2st64_b32 v[106:107], v19 offset0:33 offset1:35
    ds_read2st64_b32 v[108:109], v19 offset0:37 offset1:39
    s_waitcnt lgkmcnt(14)
    v_mfma_f32_16x16x32_bf16 v[110:113], v[78:81], v[246:249], 0
    s_waitcnt lgkmcnt(12)
    v_mfma_f32_16x16x32_bf16 v[110:113], v[82:85], v[250:253], v[110:113]
    s_waitcnt lgkmcnt(10)
    v_mfma_f32_16x16x32_bf16 v[110:113], v[86:89], v[62:65], v[110:113]
    s_waitcnt lgkmcnt(8)
    v_mfma_f32_16x16x32_bf16 v[110:113], v[90:93], v[66:69], v[110:113]
PADF93:
    s_cbranch_execz PADF94
    s_waitcnt lgkmcnt(6)
    v_mfma_f32_16x16x32_bf16 v[114:117], v[94:97], v[246:249], 0
    s_waitcnt lgkmcnt(4)
    v_mfma_f32_16x16x32_bf16 v[114:117], v[98:101], v[250:253], v[114:117]
    s_waitcnt lgkmcnt(2)
    v_mfma_f32_16x16x32_bf16 v[114:117], v[102:105], v[70:73], v[114:117]
    s_waitcnt lgkmcnt(0)
    v_mfma_f32_16x16x32_bf16 v[114:117], v[106:109], v[74:77], v[114:117]
    v_pk_fma_f32 v[54:55], v[110:111], v[134:135], v[54:55]
PADF94:
    s_cbranch_execz PADF95
    v_pk_fma_f32 v[56:57], v[112:113], v[136:137], v[56:57]
    v_cvt_pk_bf16_f32 v14, v54, v55
    v_cvt_pk_bf16_f32 v15, v56, v57
    buffer_store_dwordx2 v[14:15], v11, s[24:27], s63 offen offset:0 nt
    s_nop 2
    v_pk_fma_f32 v[58:59], v[114:115], v[138:139], v[58:59]
    v_pk_fma_f32 v[60:61], v[116:117], v[140:141], v[60:61]
    v_cvt_pk_bf16_f32 v16, v58, v59
PADF95:
    s_cbranch_execz RETF
    v_cvt_pk_bf16_f32 v17, v60, v61
    buffer_store_dwordx2 v[16:17], v11, s[24:27], s63 offen offset:32 nt
    s_endpgm
.p2align 6
SPEC:
    s_load_dwordx2 s[20:21], s[0:1], 8
    s_load_dwordx2 s[24:25], s[0:1], 16
    s_mov_b32 s22, 921600
    s_mov_b32 s23, 0x00020000
    s_mov_b32 s26, 921600
    s_mov_b32 s27, 0x00020000
    s_and_b32 s33, s3, 3
    s_lshr_b32 s34, s3, 2
    s_lshr_b32 s44, s33, 1
    s_and_b32 s45, s3, 1
    s_lshl_b32 s37, s2, 13
    s_add_u32 s37, s37, 12648448
    s_lshl_b32 s49, s2, 10
    s_add_u32 s49, s49, 12976128
    v_lshlrev_b32 v3, 10, v1
    v_mov_b32 v192, 0
    v_mov_b32 v193, 0
    v_mov_b32 v194, 0
    v_mov_b32 v195, 0
    s_cmp_lg_u32 s3, 0
    s_cbranch_scc1 W0_5
    buffer_store_dwordx4 v[192:195], v2, s[16:19], s49 offen sc1
    s_mov_b64 exec, 0xff
    buffer_store_dwordx2 v[192:193], v3, s[16:19], s37 offen offset:896 sc1
    s_mov_b64 exec, -1
W0_5:
    v_and_b32 v3, 15, v1
    s_lshl_b32 s49, s33, 4
    v_add_u32 v3, s49, v3
    v_cmp_eq_u32 vcc, 1, v3
    s_nop 1
    v_cndmask_b32 v3, v3, 64, vcc
    v_and_b32 v4, 1, v3
    v_cvt_f32_u32 v4, v4
    v_mul_f32 v4, 0xbe800000, v4
    v_lshrrev_b32 v3, 1, v3
    v_cvt_f32_u32 v3, v3
    v_mul_f32 v3, 0x3c800000, v3
    v_lshrrev_b32 v7, 4, v1
    v_lshlrev_b32 v5, 2, v7
    v_cvt_f32_u32 v5, v5
    v_fma_f32 v224, v5, v3, v4
    v_fmamk_f32 v225, v3, 0x3f800000, v224
    v_fmamk_f32 v226, v3, 0x40000000, v224
    v_fmamk_f32 v227, v3, 0x40400000, v224
    v_fmamk_f32 v228, v3, 0x41800000, v224
    v_fmamk_f32 v229, v3, 0x41880000, v224
    v_fmamk_f32 v230, v3, 0x41900000, v224
    v_fmamk_f32 v231, v3, 0x41980000, v224
    v_fmamk_f32 v232, v3, 0x42000000, v224
    v_fmamk_f32 v233, v3, 0x42040000, v224
    v_fmamk_f32 v234, v3, 0x42080000, v224
    v_fmamk_f32 v235, v3, 0x420c0000, v224
    v_fmamk_f32 v236, v3, 0x42400000, v224
    v_fmamk_f32 v237, v3, 0x42440000, v224
    v_fmamk_f32 v238, v3, 0x42480000, v224
    v_fmamk_f32 v239, v3, 0x424c0000, v224
    v_cos_f32 v224, v224
    v_cos_f32 v225, v225
    v_cos_f32 v226, v226
    v_cos_f32 v227, v227
    v_cos_f32 v228, v228
    v_cos_f32 v229, v229
    v_cos_f32 v230, v230
    v_cos_f32 v231, v231
    v_cos_f32 v232, v232
    v_cos_f32 v233, v233
    v_cos_f32 v234, v234
    v_cos_f32 v235, v235
    v_cos_f32 v236, v236
    v_cos_f32 v237, v237
    v_cos_f32 v238, v238
    v_cos_f32 v239, v239
    v_lshrrev_b32 v3, 2, v1
    v_mul_u32_u24 v3, 928, v3
    v_and_b32 v4, 3, v1
    v_lshlrev_b32 v4, 3, v4
    v_add_u32 v5, v3, v4
    v_sub_u32 v6, v3, v4
    s_lshl_b32 s42, s34, 7
    s_lshl_b32 s49, s34, 3
    s_sub_u32 s43, 32, s49
    v_add_u32 v8, s42, v5
    s_sub_u32 s49, 440, s42
    v_add_u32 v12, s49, v6
    s_add_u32 s42, s42, s43
    v_add_u32 v9, s42, v5
    s_sub_u32 s49, 440, s42
    v_add_u32 v13, s49, v6
    s_add_u32 s42, s42, s43
    v_add_u32 v10, s42, v5
    s_sub_u32 s49, 440, s42
    v_add_u32 v14, s49, v6
    s_add_u32 s42, s42, s43
    v_add_u32 v11, s42, v5
    s_sub_u32 s49, 440, s42
    v_add_u32 v15, s49, v6
    v_lshrrev_b32 v3, 3, v1
    v_mul_u32_u24 v4, 928, v3
    v_and_b32 v5, 7, v1
    v_lshl_add_u32 v4, v5, 4, v4
    v_add_u32 v4, s36, v4
    s_lshl_b32 s49, s3, 5
    s_add_u32 s49, s49, 148480
    v_lshl_add_u32 v5, v3, 2, s49
    s_lshl_b32 s49, s34, 6
    s_lshl_b32 s46, s45, 5
    s_add_u32 s49, s49, s46
    s_lshl_b32 s46, s44, 3
    s_add_u32 s49, s49, s46
    s_add_u32 s49, s49, 148736
    v_lshrrev_b32 v6, 5, v1
    v_lshl_add_u32 v6, v6, 4, s49
    v_and_b32 v196, 3, v3
    v_lshl_add_u32 v6, v196, 1, v6
    s_lshl_b32 s46, s45, 7
    s_lshr_b32 s49, s3, 1
    s_lshl_b32 s49, s49, 2
    s_add_u32 s46, s46, s49
    s_add_u32 s46, s46, 148992
    v_lshl_add_u32 v196, v3, 4, s46
    v_lshlrev_b32 v3, 2, v1
    v_add_u32 v212, 148992, v3
    s_lshl_b32 s46, s2, 8
    s_add_u32 s46, s46, 12582912
    v_lshlrev_b32 v7, 4, v7
    v_add_u32 v7, 148480, v7
    v_and_b32 v176, 31, v1
    v_lshrrev_b32 v177, 5, v1
    v_lshlrev_b32 v177, 2, v177
    s_lshl_b32 s49, s44, 4
    v_add_u32 v177, s49, v177
    s_cmp_eq_u32 s34, 0
    s_cselect_b64 vcc, -1, 0
    v_cndmask_b32 v178, v177, v176, vcc
    v_cndmask_b32 v179, v176, v177, vcc
    v_cmp_le_u32 s[62:63], 16, v178
    v_cmp_eq_u32 s[50:51], 0, v178
    s_cmp_eq_u32 s2, 0
    s_cselect_b64 s[52:53], -1, 0
    s_and_b64 s[54:55], s[62:63], s[52:53]
    s_and_b64 s[50:51], s[50:51], s[52:53]
    s_cmp_eq_u32 s45, 1
    s_cselect_b64 s[50:51], s[50:51], 0
    s_and_b64 s[56:57], s[50:51], vcc
    v_lshlrev_b32 v178, 6, v178
    v_add_u32 v178, s2, v178
    v_subrev_u32 v176, 992, v178
    v_cndmask_b32 v178, v178, v176, s[54:55]
    v_mov_b32 v176, 1024
    v_cndmask_b32 v178, v178, v176, s[56:57]
    v_cvt_f32_u32 v178, v178
    v_cvt_f32_u32 v179, v179
    v_mul_f32 v178, 0x3a000000, v178
    v_mul_f32 v176, 0x3d000000, v179
    v_cndmask_b32 v176, v176, v178, vcc
    s_cmp_eq_u32 s45, 1
    s_cselect_b32 s49, 0xbe800000, 0
    v_mov_b32 v177, s49
    v_cndmask_b32 v177, v177, 0, s[56:57]
    v_fma_f32 v160, v178, v179, v177
    v_fmamk_f32 v161, v176, 0x3f800000, v160
    v_fmamk_f32 v162, v176, 0x40000000, v160
    v_fmamk_f32 v163, v176, 0x40400000, v160
    v_fmamk_f32 v164, v176, 0x41000000, v160
    v_fmamk_f32 v165, v176, 0x41100000, v160
    v_fmamk_f32 v166, v176, 0x41200000, v160
    v_fmamk_f32 v167, v176, 0x41300000, v160
    v_mul_f32 v179, 0.5, v179
    v_cndmask_b32 v160, v160, v179, s[50:51]
    v_cos_f32 v160, v160
    v_cos_f32 v161, v161
    v_cos_f32 v162, v162
    v_cos_f32 v163, v163
    v_cos_f32 v164, v164
    v_cos_f32 v165, v165
    v_cos_f32 v166, v166
    v_cos_f32 v167, v167
    v_cvt_pk_bf16_f32 v168, v160, v161
    v_cvt_pk_bf16_f32 v169, v162, v163
    v_cvt_pk_bf16_f32 v170, v164, v165
    v_cvt_pk_bf16_f32 v171, v166, v167
    s_andn2_b64 s[58:59], s[52:53], s[62:63]
    s_cmp_lg_u32 s2, 0
    s_cselect_b32 s49, s45, 0
    s_mul_i32 s49, s49, 0x80008000
    v_xor_b32 v172, s49, v168
    v_xor_b32 v173, s49, v169
    v_xor_b32 v174, s49, v170
    v_xor_b32 v175, s49, v171
    v_cndmask_b32 v172, v172, 0, s[58:59]
    v_cndmask_b32 v173, v173, 0, s[58:59]
    v_cndmask_b32 v174, v174, 0, s[58:59]
    v_cndmask_b32 v175, v175, 0, s[58:59]
    v_cndmask_b32 v168, v168, 0, s[54:55]
    v_cndmask_b32 v169, v169, 0, s[54:55]
    v_cndmask_b32 v170, v170, 0, s[54:55]
    v_cndmask_b32 v171, v171, 0, s[54:55]
    s_lshl_b32 s60, s34, 3
    s_add_u32 s60, s60, s44
    s_lshl_b32 s60, s60, 10
    s_add_u32 s60, s60, 132096
    s_mul_i32 s49, s45, 6144
    s_add_u32 s49, s49, s60
    v_add_u32 v176, s49, v2
    s_cmp_eq_u32 s2, 0
    s_cselect_b32 s49, 0, 1
    s_xor_b32 s49, s49, s45
    s_lshl_b32 s49, s49, 11
    s_add_u32 s49, s49, s60
    v_add_u32 v177, s49, v2
    ds_write_b128 v176, v[168:171]
    ds_write_b128 v177, v[172:175] offset:2048
    s_lshl_b32 s38, s3, 8
    s_add_u32 s38, s38, s2
    s_mul_i32 s49, s34, 992
    s_cmp_eq_u32 s2, 0
    s_cselect_b32 s49, s49, 0
    s_sub_u32 s38, s38, s49
    s_sub_u32 s39, 2048, s38
    s_cmp_eq_u32 s38, 0
    s_cselect_b32 s40, 1024, s39
    v_and_b32 v124, 31, v1
    v_lshlrev_b32 v124, 4, v124
    v_cmp_gt_u32 vcc, 32, v1
    v_mov_b32 v125, s38
    v_mov_b32 v126, s39
    v_mov_b32 v127, s40
    v_cndmask_b32 v126, v126, v125, vcc
    v_cndmask_b32 v127, v127, v125, vcc
    v_mul_u32_u24 v126, 450, v126
    v_mul_u32_u24 v127, 450, v127
    v_and_b32 v126, 0xffffffc0, v126
    v_and_b32 v127, 0xffffffc0, v127
    v_add_u32 v126, v126, v124
    v_add_u32 v127, v127, v124
    v_mov_b32 v124, 0xffff8f80
    v_mov_b32 v125, 28800
    v_cndmask_b32 v124, v124, v125, vcc
    s_lshl_b32 s41, s3, 13
    s_waitcnt lgkmcnt(0)
    s_barrier
    s_add_u32 m0, s41, 66560
    s_nop 0
    buffer_load_dwordx4 v127, s[20:23], 0 offen lds
    s_add_u32 m0, s41, 67584
    s_nop 0
    buffer_load_dwordx4 v127, s[24:27], 0 offen lds
    v_add_u32 v126, v126, v124
    s_add_u32 m0, s41, 68608
    s_nop 0
    buffer_load_dwordx4 v126, s[20:23], 0 offen lds
    s_add_u32 m0, s41, 69632
    s_nop 0
    buffer_load_dwordx4 v126, s[24:27], 0 offen lds
    s_setprio 3
    s_waitcnt vmcnt(4)
    ds_read_b128 v[128:131], v4 offset:0
    ds_read_b128 v[132:135], v4 offset:128
    ds_read_b128 v[136:139], v4 offset:256
    ds_read_b128 v[140:143], v4 offset:384
    ds_read_b128 v[144:147], v4 offset:512
    ds_read_b128 v[148:151], v4 offset:640
    ds_read_b128 v[152:155], v4 offset:768
    s_waitcnt lgkmcnt(6)
    v_dot2c_f32_bf16 v192, 0x3f803f80, v128
    v_dot2c_f32_bf16 v194, v128, v128
    v_dot2c_f32_bf16 v193, 0x3f803f80, v129
    v_dot2c_f32_bf16 v195, v129, v129
    v_dot2c_f32_bf16 v192, 0x3f803f80, v130
    v_dot2c_f32_bf16 v194, v130, v130
    v_dot2c_f32_bf16 v193, 0x3f803f80, v131
    v_dot2c_f32_bf16 v195, v131, v131
    s_waitcnt lgkmcnt(5)
    v_dot2c_f32_bf16 v192, 0x3f803f80, v132
    v_dot2c_f32_bf16 v194, v132, v132
    v_dot2c_f32_bf16 v193, 0x3f803f80, v133
    v_dot2c_f32_bf16 v195, v133, v133
    v_dot2c_f32_bf16 v192, 0x3f803f80, v134
    v_dot2c_f32_bf16 v194, v134, v134
    v_dot2c_f32_bf16 v193, 0x3f803f80, v135
    v_dot2c_f32_bf16 v195, v135, v135
    s_waitcnt lgkmcnt(4)
    v_dot2c_f32_bf16 v192, 0x3f803f80, v136
    v_dot2c_f32_bf16 v194, v136, v136
    v_dot2c_f32_bf16 v193, 0x3f803f80, v137
    v_dot2c_f32_bf16 v195, v137, v137
    v_dot2c_f32_bf16 v192, 0x3f803f80, v138
    v_dot2c_f32_bf16 v194, v138, v138
    v_dot2c_f32_bf16 v193, 0x3f803f80, v139
    v_dot2c_f32_bf16 v195, v139, v139
    s_waitcnt lgkmcnt(3)
    v_dot2c_f32_bf16 v192, 0x3f803f80, v140
    v_dot2c_f32_bf16 v194, v140, v140
    v_dot2c_f32_bf16 v193, 0x3f803f80, v141
    v_dot2c_f32_bf16 v195, v141, v141
    v_dot2c_f32_bf16 v192, 0x3f803f80, v142
    v_dot2c_f32_bf16 v194, v142, v142
    v_dot2c_f32_bf16 v193, 0x3f803f80, v143
    v_dot2c_f32_bf16 v195, v143, v143
    s_waitcnt lgkmcnt(2)
    v_dot2c_f32_bf16 v192, 0x3f803f80, v144
    v_dot2c_f32_bf16 v194, v144, v144
    v_dot2c_f32_bf16 v193, 0x3f803f80, v145
    v_dot2c_f32_bf16 v195, v145, v145
    v_dot2c_f32_bf16 v192, 0x3f803f80, v146
    v_dot2c_f32_bf16 v194, v146, v146
    v_dot2c_f32_bf16 v193, 0x3f803f80, v147
    v_dot2c_f32_bf16 v195, v147, v147
    s_waitcnt lgkmcnt(1)
    v_dot2c_f32_bf16 v192, 0x3f803f80, v148
    v_dot2c_f32_bf16 v194, v148, v148
    v_dot2c_f32_bf16 v193, 0x3f803f80, v149
    v_dot2c_f32_bf16 v195, v149, v149
    v_dot2c_f32_bf16 v192, 0x3f803f80, v150
    v_dot2c_f32_bf16 v194, v150, v150
    v_dot2c_f32_bf16 v193, 0x3f803f80, v151
    v_dot2c_f32_bf16 v195, v151, v151
    s_waitcnt lgkmcnt(0)
    v_dot2c_f32_bf16 v192, 0x3f803f80, v152
    v_dot2c_f32_bf16 v194, v152, v152
    v_dot2c_f32_bf16 v193, 0x3f803f80, v153
    v_dot2c_f32_bf16 v195, v153, v153
    v_dot2c_f32_bf16 v192, 0x3f803f80, v154
    v_dot2c_f32_bf16 v194, v154, v154
    v_dot2c_f32_bf16 v193, 0x3f803f80, v155
    v_dot2c_f32_bf16 v195, v155, v155
    s_nop 1
    v_add_f32 v192, v192, v193
    v_add_f32 v194, v194, v195
    s_nop 0
    v_add_f32_dpp v192, v192, v192 quad_perm:[1,0,3,2] row_mask:0xf bank_mask:0xf
    v_add_f32_dpp v194, v194, v194 quad_perm:[1,0,3,2] row_mask:0xf bank_mask:0xf
    s_nop 0
    v_add_f32_dpp v192, v192, v192 quad_perm:[2,3,0,1] row_mask:0xf bank_mask:0xf
    v_add_f32_dpp v194, v194, v194 quad_perm:[2,3,0,1] row_mask:0xf bank_mask:0xf
    s_nop 0
    v_add_f32_dpp v192, v192, v192 row_half_mirror row_mask:0xf bank_mask:0xf
    v_add_f32_dpp v194, v194, v194 row_half_mirror row_mask:0xf bank_mask:0xf
    v_mul_f32 v192, 0x3b124925, v192
    v_mul_f32 v194, 0x3b124925, v194
    v_fma_f32 v194, -v192, v192, v194
    v_max_f32 v194, 0, v194
    v_cvt_pk_bf16_f32 v194, v194, v194
    v_lshlrev_b32 v194, 16, v194
    v_add_f32 v194, 0x3727c5ac, v194
    v_cvt_pk_bf16_f32 v194, v194, v194
    v_lshlrev_b32 v194, 16, v194
    v_sqrt_f32 v194, v194
    s_nop 0
    v_cvt_pk_bf16_f32 v193, v194, -v192
    v_lshlrev_b32 v194, 16, v193
    v_rcp_f32 v195, v194
    s_mov_b32 exec_lo, 0x01010101
    s_mov_b32 exec_hi, 0x01010101
    ds_write_b16_d16_hi v6, v193
    ds_write_b32 v5, v195
    ds_write_b32 v196, v193
    s_mov_b64 exec, -1
    s_waitcnt lgkmcnt(0)
    s_barrier
    ds_read_b32 v5, v212
    ds_read_b128 v[240:243], v7 offset:0
    ds_read_b128 v[244:247], v7 offset:64
    ds_read_b128 v[248:251], v7 offset:128
    ds_read_b128 v[252:255], v7 offset:192
    ds_read_b128 v[192:195], v7 offset:256
    ds_read_b128 v[196:199], v7 offset:320
    ds_read_b64_tr_b16 v[16:17], v8 offset:0
    ds_read_b64_tr_b16 v[18:19], v8 offset:14848
    ds_read_b64_tr_b16 v[20:21], v8 offset:29696
    ds_read_b64_tr_b16 v[22:23], v8 offset:44544
    ds_read_b64_tr_b16 v[24:25], v8 offset:448
    ds_read_b64_tr_b16 v[26:27], v8 offset:15296
    ds_read_b64_tr_b16 v[28:29], v8 offset:30144
    ds_read_b64_tr_b16 v[30:31], v8 offset:44992
    s_waitcnt lgkmcnt(13)
    v_pk_mul_f32 v[224:225], v[224:225], v[240:241]
    v_pk_mul_f32 v[226:227], v[226:227], v[242:243]
    s_waitcnt lgkmcnt(12)
    v_pk_mul_f32 v[228:229], v[228:229], v[244:245]
    v_pk_mul_f32 v[230:231], v[230:231], v[246:247]
    s_waitcnt lgkmcnt(11)
    v_pk_mul_f32 v[232:233], v[232:233], v[248:249]
    v_pk_mul_f32 v[234:235], v[234:235], v[250:251]
    s_waitcnt lgkmcnt(10)
    v_pk_mul_f32 v[236:237], v[236:237], v[252:253]
    v_pk_mul_f32 v[238:239], v[238:239], v[254:255]
    s_cmp_lg_u32 s3, 0
    s_cbranch_scc1 W0_6
    buffer_store_dword v5, v3, s[16:19], s46 offen sc1
W0_6:
    ds_read_b64_tr_b16 v[32:33], v12 offset:0
    ds_read_b64_tr_b16 v[34:35], v12 offset:14848
    ds_read_b64_tr_b16 v[36:37], v12 offset:29696
    ds_read_b64_tr_b16 v[38:39], v12 offset:44544
    ds_read_b64_tr_b16 v[40:41], v12 offset:448
    ds_read_b64_tr_b16 v[42:43], v12 offset:15296
    ds_read_b64_tr_b16 v[44:45], v12 offset:30144
    ds_read_b64_tr_b16 v[46:47], v12 offset:44992
    ds_read_b64_tr_b16 v[48:49], v9 offset:0
    ds_read_b64_tr_b16 v[50:51], v9 offset:14848
    ds_read_b64_tr_b16 v[52:53], v9 offset:29696
    ds_read_b64_tr_b16 v[54:55], v9 offset:44544
    v_cvt_pk_bf16_f32 v200, v224, v225
    v_cvt_pk_bf16_f32 v201, v226, v227
    v_cvt_pk_bf16_f32 v202, v228, v229
    v_cvt_pk_bf16_f32 v203, v230, v231
    v_cvt_pk_bf16_f32 v204, v232, v233
    v_cvt_pk_bf16_f32 v205, v234, v235
    v_cvt_pk_bf16_f32 v206, v236, v237
    v_cvt_pk_bf16_f32 v207, v238, v239
    s_waitcnt lgkmcnt(15)
    v_mfma_f32_16x16x32_bf16 v[208:211], v[200:203], v[192:195], 0
    v_mfma_f32_16x16x32_bf16 v[208:211], v[204:207], v[196:199], v[208:211]
    ds_read_b64_tr_b16 v[56:57], v9 offset:448
    ds_read_b64_tr_b16 v[58:59], v9 offset:15296
    ds_read_b64_tr_b16 v[60:61], v9 offset:30144
    ds_read_b64_tr_b16 v[62:63], v9 offset:44992
    ds_read_b64_tr_b16 v[64:65], v13 offset:0
    ds_read_b64_tr_b16 v[66:67], v13 offset:14848
    ds_read_b64_tr_b16 v[68:69], v13 offset:29696
    ds_read_b64_tr_b16 v[70:71], v13 offset:44544
    v_mfma_f32_16x16x32_bf16 v[128:131], v[200:203], v[16:19], v[208:211]
    ds_read_b64_tr_b16 v[16:17], v13 offset:448
    ds_read_b64_tr_b16 v[18:19], v13 offset:15296
    v_mfma_f32_16x16x32_bf16 v[128:131], v[204:207], v[20:23], v[128:131]
    ds_read_b64_tr_b16 v[20:21], v13 offset:30144
    ds_read_b64_tr_b16 v[22:23], v13 offset:44992
    v_add_u32 v126, v126, v124
    s_add_u32 m0, s41, 70656
    s_nop 0
    buffer_load_dwordx4 v126, s[20:23], 0 offen lds
    s_waitcnt lgkmcnt(15)
    v_mfma_f32_16x16x32_bf16 v[132:135], v[200:203], v[24:27], v[208:211]
    ds_read_b64_tr_b16 v[24:25], v10 offset:0
    ds_read_b64_tr_b16 v[26:27], v10 offset:14848
    v_mfma_f32_16x16x32_bf16 v[132:135], v[204:207], v[28:31], v[132:135]
    ds_read_b64_tr_b16 v[28:29], v10 offset:29696
    ds_read_b64_tr_b16 v[30:31], v10 offset:44544
    s_add_u32 m0, s41, 71680
    s_nop 0
    buffer_load_dwordx4 v126, s[24:27], 0 offen lds
    v_mfma_f32_16x16x32_bf16 v[136:139], v[200:203], v[32:35], v[208:211]
    ds_read_b64_tr_b16 v[32:33], v10 offset:448
    ds_read_b64_tr_b16 v[34:35], v10 offset:15296
    v_mfma_f32_16x16x32_bf16 v[136:139], v[204:207], v[36:39], v[136:139]
    ds_read_b64_tr_b16 v[36:37], v10 offset:30144
    ds_read_b64_tr_b16 v[38:39], v10 offset:44992
    v_add_u32 v126, v126, v124
    s_add_u32 m0, s41, 72704
    s_nop 0
    buffer_load_dwordx4 v126, s[20:23], 0 offen lds
    v_mfma_f32_16x16x32_bf16 v[140:143], v[200:203], v[40:43], v[208:211]
    ds_read_b64_tr_b16 v[40:41], v14 offset:0
    ds_read_b64_tr_b16 v[42:43], v14 offset:14848
    v_mfma_f32_16x16x32_bf16 v[140:143], v[204:207], v[44:47], v[140:143]
    ds_read_b64_tr_b16 v[44:45], v14 offset:29696
    ds_read_b64_tr_b16 v[46:47], v14 offset:44544
    s_add_u32 m0, s41, 73728
    s_nop 0
    buffer_load_dwordx4 v126, s[24:27], 0 offen lds
    s_waitcnt lgkmcnt(15)
    v_mfma_f32_16x16x32_bf16 v[144:147], v[200:203], v[48:51], v[208:211]
    ds_read_b64_tr_b16 v[48:49], v14 offset:448
    ds_read_b64_tr_b16 v[50:51], v14 offset:15296
    v_mfma_f32_16x16x32_bf16 v[144:147], v[204:207], v[52:55], v[144:147]
    ds_read_b64_tr_b16 v[52:53], v14 offset:30144
    ds_read_b64_tr_b16 v[54:55], v14 offset:44992
    v_mfma_f32_16x16x32_bf16 v[148:151], v[200:203], v[56:59], v[208:211]
    ds_read_b64_tr_b16 v[56:57], v11 offset:0
    ds_read_b64_tr_b16 v[58:59], v11 offset:14848
    v_pk_add_f32 v[224:225], v[128:129], v[132:133] neg_lo:[0,1] neg_hi:[0,1]
    v_pk_add_f32 v[128:129], v[128:129], v[132:133]
    v_pk_add_f32 v[226:227], v[130:131], v[134:135] neg_lo:[0,1] neg_hi:[0,1]
    v_pk_add_f32 v[130:131], v[130:131], v[134:135]
    v_mfma_f32_16x16x32_bf16 v[148:151], v[204:207], v[60:63], v[148:151]
    ds_read_b64_tr_b16 v[60:61], v11 offset:29696
    ds_read_b64_tr_b16 v[62:63], v11 offset:44544
    v_pk_add_f32 v[228:229], v[136:137], v[140:141] neg_lo:[0,1] neg_hi:[0,1]
    v_pk_add_f32 v[136:137], v[136:137], v[140:141]
    v_pk_add_f32 v[230:231], v[138:139], v[142:143] neg_lo:[0,1] neg_hi:[0,1]
    v_pk_add_f32 v[138:139], v[138:139], v[142:143]
    v_mfma_f32_16x16x32_bf16 v[152:155], v[200:203], v[64:67], v[208:211]
    ds_read_b64_tr_b16 v[64:65], v11 offset:448
    ds_read_b64_tr_b16 v[66:67], v11 offset:15296
    v_subrev_f32_dpp v132, v136, v128 quad_perm:[3,2,1,0] row_mask:0xf bank_mask:0xf
    v_add_f32_dpp v128, v136, v128 quad_perm:[3,2,1,0] row_mask:0xf bank_mask:0xf
    v_subrev_f32_dpp v133, v137, v129 quad_perm:[3,2,1,0] row_mask:0xf bank_mask:0xf
    v_add_f32_dpp v129, v137, v129 quad_perm:[3,2,1,0] row_mask:0xf bank_mask:0xf
    v_mfma_f32_16x16x32_bf16 v[152:155], v[204:207], v[68:71], v[152:155]
    ds_read_b64_tr_b16 v[68:69], v11 offset:30144
    ds_read_b64_tr_b16 v[70:71], v11 offset:44992
    v_subrev_f32_dpp v134, v138, v130 quad_perm:[3,2,1,0] row_mask:0xf bank_mask:0xf
    v_add_f32_dpp v130, v138, v130 quad_perm:[3,2,1,0] row_mask:0xf bank_mask:0xf
    v_subrev_f32_dpp v135, v139, v131 quad_perm:[3,2,1,0] row_mask:0xf bank_mask:0xf
    v_add_f32_dpp v131, v139, v131 quad_perm:[3,2,1,0] row_mask:0xf bank_mask:0xf
    s_waitcnt lgkmcnt(15)
    v_mfma_f32_16x16x32_bf16 v[156:159], v[200:203], v[16:19], v[208:211]
    ds_read_b64_tr_b16 v[16:17], v15 offset:0
    ds_read_b64_tr_b16 v[18:19], v15 offset:14848
    v_subrev_f32_dpp v136, v228, v224 quad_perm:[3,2,1,0] row_mask:0xf bank_mask:0xf
    v_add_f32_dpp v140, v228, v224 quad_perm:[3,2,1,0] row_mask:0xf bank_mask:0xf
    v_subrev_f32_dpp v137, v229, v225 quad_perm:[3,2,1,0] row_mask:0xf bank_mask:0xf
    v_add_f32_dpp v141, v229, v225 quad_perm:[3,2,1,0] row_mask:0xf bank_mask:0xf
    v_mfma_f32_16x16x32_bf16 v[156:159], v[204:207], v[20:23], v[156:159]
    ds_read_b64_tr_b16 v[20:21], v15 offset:29696
    ds_read_b64_tr_b16 v[22:23], v15 offset:44544
    v_subrev_f32_dpp v138, v230, v226 quad_perm:[3,2,1,0] row_mask:0xf bank_mask:0xf
    v_add_f32_dpp v142, v230, v226 quad_perm:[3,2,1,0] row_mask:0xf bank_mask:0xf
    v_subrev_f32_dpp v139, v231, v227 quad_perm:[3,2,1,0] row_mask:0xf bank_mask:0xf
    v_add_f32_dpp v143, v231, v227 quad_perm:[3,2,1,0] row_mask:0xf bank_mask:0xf
    v_mfma_f32_16x16x32_bf16 v[160:163], v[200:203], v[24:27], v[208:211]
    ds_read_b64_tr_b16 v[24:25], v15 offset:448
    ds_read_b64_tr_b16 v[26:27], v15 offset:15296
    v_mfma_f32_16x16x32_bf16 v[160:163], v[204:207], v[28:31], v[160:163]
    ds_read_b64_tr_b16 v[28:29], v15 offset:30144
    ds_read_b64_tr_b16 v[30:31], v15 offset:44992
    v_mfma_f32_16x16x32_bf16 v[164:167], v[200:203], v[32:35], v[208:211]
    v_pk_add_f32 v[232:233], v[144:145], v[148:149] neg_lo:[0,1] neg_hi:[0,1]
    v_pk_add_f32 v[144:145], v[144:145], v[148:149]
    v_pk_add_f32 v[234:235], v[146:147], v[150:151] neg_lo:[0,1] neg_hi:[0,1]
    v_pk_add_f32 v[146:147], v[146:147], v[150:151]
    v_mfma_f32_16x16x32_bf16 v[164:167], v[204:207], v[36:39], v[164:167]
    v_pk_add_f32 v[236:237], v[152:153], v[156:157] neg_lo:[0,1] neg_hi:[0,1]
    v_pk_add_f32 v[152:153], v[152:153], v[156:157]
    v_pk_add_f32 v[238:239], v[154:155], v[158:159] neg_lo:[0,1] neg_hi:[0,1]
    v_pk_add_f32 v[154:155], v[154:155], v[158:159]
    s_waitcnt lgkmcnt(15)
    v_mfma_f32_16x16x32_bf16 v[168:171], v[200:203], v[40:43], v[208:211]
    v_subrev_f32_dpp v148, v152, v144 quad_perm:[3,2,1,0] row_mask:0xf bank_mask:0xf
    v_add_f32_dpp v144, v152, v144 quad_perm:[3,2,1,0] row_mask:0xf bank_mask:0xf
    v_subrev_f32_dpp v149, v153, v145 quad_perm:[3,2,1,0] row_mask:0xf bank_mask:0xf
    v_add_f32_dpp v145, v153, v145 quad_perm:[3,2,1,0] row_mask:0xf bank_mask:0xf
    v_mfma_f32_16x16x32_bf16 v[168:171], v[204:207], v[44:47], v[168:171]
    v_subrev_f32_dpp v150, v154, v146 quad_perm:[3,2,1,0] row_mask:0xf bank_mask:0xf
    v_add_f32_dpp v146, v154, v146 quad_perm:[3,2,1,0] row_mask:0xf bank_mask:0xf
    v_subrev_f32_dpp v151, v155, v147 quad_perm:[3,2,1,0] row_mask:0xf bank_mask:0xf
    v_add_f32_dpp v147, v155, v147 quad_perm:[3,2,1,0] row_mask:0xf bank_mask:0xf
    v_mfma_f32_16x16x32_bf16 v[172:175], v[200:203], v[48:51], v[208:211]
    v_subrev_f32_dpp v152, v236, v232 quad_perm:[3,2,1,0] row_mask:0xf bank_mask:0xf
    v_add_f32_dpp v156, v236, v232 quad_perm:[3,2,1,0] row_mask:0xf bank_mask:0xf
    v_subrev_f32_dpp v153, v237, v233 quad_perm:[3,2,1,0] row_mask:0xf bank_mask:0xf
    v_add_f32_dpp v157, v237, v233 quad_perm:[3,2,1,0] row_mask:0xf bank_mask:0xf
    v_mfma_f32_16x16x32_bf16 v[172:175], v[204:207], v[52:55], v[172:175]
    v_subrev_f32_dpp v154, v238, v234 quad_perm:[3,2,1,0] row_mask:0xf bank_mask:0xf
    v_add_f32_dpp v158, v238, v234 quad_perm:[3,2,1,0] row_mask:0xf bank_mask:0xf
    v_subrev_f32_dpp v155, v239, v235 quad_perm:[3,2,1,0] row_mask:0xf bank_mask:0xf
    v_add_f32_dpp v159, v239, v235 quad_perm:[3,2,1,0] row_mask:0xf bank_mask:0xf
    s_waitcnt lgkmcnt(14)
    v_mfma_f32_16x16x32_bf16 v[176:179], v[200:203], v[56:59], v[208:211]
    s_waitcnt lgkmcnt(12)
    v_mfma_f32_16x16x32_bf16 v[176:179], v[204:207], v[60:63], v[176:179]
    s_waitcnt lgkmcnt(10)
    v_mfma_f32_16x16x32_bf16 v[180:183], v[200:203], v[64:67], v[208:211]
    v_pk_add_f32 v[224:225], v[160:161], v[164:165] neg_lo:[0,1] neg_hi:[0,1]
    v_pk_add_f32 v[160:161], v[160:161], v[164:165]
    v_pk_add_f32 v[226:227], v[162:163], v[166:167] neg_lo:[0,1] neg_hi:[0,1]
    v_pk_add_f32 v[162:163], v[162:163], v[166:167]
    s_waitcnt lgkmcnt(8)
    v_mfma_f32_16x16x32_bf16 v[180:183], v[204:207], v[68:71], v[180:183]
    v_pk_add_f32 v[228:229], v[168:169], v[172:173] neg_lo:[0,1] neg_hi:[0,1]
    v_pk_add_f32 v[168:169], v[168:169], v[172:173]
    v_pk_add_f32 v[230:231], v[170:171], v[174:175] neg_lo:[0,1] neg_hi:[0,1]
    v_pk_add_f32 v[170:171], v[170:171], v[174:175]
    s_waitcnt lgkmcnt(6)
    v_mfma_f32_16x16x32_bf16 v[184:187], v[200:203], v[16:19], v[208:211]
    v_subrev_f32_dpp v164, v168, v160 quad_perm:[3,2,1,0] row_mask:0xf bank_mask:0xf
    v_add_f32_dpp v160, v168, v160 quad_perm:[3,2,1,0] row_mask:0xf bank_mask:0xf
    v_subrev_f32_dpp v165, v169, v161 quad_perm:[3,2,1,0] row_mask:0xf bank_mask:0xf
    v_add_f32_dpp v161, v169, v161 quad_perm:[3,2,1,0] row_mask:0xf bank_mask:0xf
    s_waitcnt lgkmcnt(4)
    v_mfma_f32_16x16x32_bf16 v[184:187], v[204:207], v[20:23], v[184:187]
    v_subrev_f32_dpp v166, v170, v162 quad_perm:[3,2,1,0] row_mask:0xf bank_mask:0xf
    v_add_f32_dpp v162, v170, v162 quad_perm:[3,2,1,0] row_mask:0xf bank_mask:0xf
    v_subrev_f32_dpp v167, v171, v163 quad_perm:[3,2,1,0] row_mask:0xf bank_mask:0xf
    v_add_f32_dpp v163, v171, v163 quad_perm:[3,2,1,0] row_mask:0xf bank_mask:0xf
    s_waitcnt lgkmcnt(2)
    v_mfma_f32_16x16x32_bf16 v[188:191], v[200:203], v[24:27], v[208:211]
    v_subrev_f32_dpp v168, v228, v224 quad_perm:[3,2,1,0] row_mask:0xf bank_mask:0xf
    v_add_f32_dpp v172, v228, v224 quad_perm:[3,2,1,0] row_mask:0xf bank_mask:0xf
    v_subrev_f32_dpp v169, v229, v225 quad_perm:[3,2,1,0] row_mask:0xf bank_mask:0xf
    v_add_f32_dpp v173, v229, v225 quad_perm:[3,2,1,0] row_mask:0xf bank_mask:0xf
    s_waitcnt lgkmcnt(0)
    v_mfma_f32_16x16x32_bf16 v[188:191], v[204:207], v[28:31], v[188:191]
    v_subrev_f32_dpp v170, v230, v226 quad_perm:[3,2,1,0] row_mask:0xf bank_mask:0xf
    v_add_f32_dpp v174, v230, v226 quad_perm:[3,2,1,0] row_mask:0xf bank_mask:0xf
    v_subrev_f32_dpp v171, v231, v227 quad_perm:[3,2,1,0] row_mask:0xf bank_mask:0xf
    v_add_f32_dpp v175, v231, v227 quad_perm:[3,2,1,0] row_mask:0xf bank_mask:0xf
    v_mov_b32 v3, 1
    s_lshl_b32 s49, s2, 3
    s_cmp_lg_u32 s3, 0
    s_cbranch_scc1 W0_7
    s_waitcnt vmcnt(4)
    s_mov_b64 exec, 1
    buffer_store_dword v3, off, s[28:31], s49 sc1
    s_mov_b64 exec, -1
W0_7:
    v_lshrrev_b32 v4, 4, v1
    v_lshlrev_b32 v4, 17, v4
    v_and_b32 v5, 15, v1
    v_lshl_add_u32 v4, v5, 4, v4
    s_lshl_b32 s46, s33, 19
    s_lshl_b32 s49, s2, 11
    s_add_u32 s46, s46, s49
    s_lshl_b32 s49, s34, 10
    s_add_u32 s46, s46, s49
    s_add_u32 s46, s46, 8388608
    s_add_u32 s47, s46, 65536
    v_pk_add_f32 v[232:233], v[176:177], v[180:181] neg_lo:[0,1] neg_hi:[0,1]
    v_pk_add_f32 v[176:177], v[176:177], v[180:181]
    v_pk_add_f32 v[234:235], v[178:179], v[182:183] neg_lo:[0,1] neg_hi:[0,1]
    v_pk_add_f32 v[178:179], v[178:179], v[182:183]
    v_pk_add_f32 v[236:237], v[184:185], v[188:189] neg_lo:[0,1] neg_hi:[0,1]
    v_pk_add_f32 v[184:185], v[184:185], v[188:189]
    v_pk_add_f32 v[238:239], v[186:187], v[190:191] neg_lo:[0,1] neg_hi:[0,1]
    v_pk_add_f32 v[186:187], v[186:187], v[190:191]
    v_subrev_f32_dpp v180, v184, v176 quad_perm:[3,2,1,0] row_mask:0xf bank_mask:0xf
    v_add_f32_dpp v176, v184, v176 quad_perm:[3,2,1,0] row_mask:0xf bank_mask:0xf
    v_subrev_f32_dpp v181, v185, v177 quad_perm:[3,2,1,0] row_mask:0xf bank_mask:0xf
    v_add_f32_dpp v177, v185, v177 quad_perm:[3,2,1,0] row_mask:0xf bank_mask:0xf
    v_subrev_f32_dpp v182, v186, v178 quad_perm:[3,2,1,0] row_mask:0xf bank_mask:0xf
    v_add_f32_dpp v178, v186, v178 quad_perm:[3,2,1,0] row_mask:0xf bank_mask:0xf
    v_subrev_f32_dpp v183, v187, v179 quad_perm:[3,2,1,0] row_mask:0xf bank_mask:0xf
    v_add_f32_dpp v179, v187, v179 quad_perm:[3,2,1,0] row_mask:0xf bank_mask:0xf
    v_subrev_f32_dpp v184, v236, v232 quad_perm:[3,2,1,0] row_mask:0xf bank_mask:0xf
    v_add_f32_dpp v188, v236, v232 quad_perm:[3,2,1,0] row_mask:0xf bank_mask:0xf
    v_subrev_f32_dpp v185, v237, v233 quad_perm:[3,2,1,0] row_mask:0xf bank_mask:0xf
    v_add_f32_dpp v189, v237, v233 quad_perm:[3,2,1,0] row_mask:0xf bank_mask:0xf
    v_subrev_f32_dpp v186, v238, v234 quad_perm:[3,2,1,0] row_mask:0xf bank_mask:0xf
    v_add_f32_dpp v190, v238, v234 quad_perm:[3,2,1,0] row_mask:0xf bank_mask:0xf
    v_subrev_f32_dpp v187, v239, v235 quad_perm:[3,2,1,0] row_mask:0xf bank_mask:0xf
    v_add_f32_dpp v191, v239, v235 quad_perm:[3,2,1,0] row_mask:0xf bank_mask:0xf
    v_cvt_pk_bf16_f32 v192, v128, v144
    v_cvt_pk_bf16_f32 v193, v160, v176
    v_cvt_pk_bf16_f32 v194, v132, v148
    v_cvt_pk_bf16_f32 v195, v164, v180
    buffer_store_dwordx4 v[192:195], v4, s[16:19], s46 offen offset:0 sc1
    v_cvt_pk_bf16_f32 v196, v136, v152
    v_cvt_pk_bf16_f32 v197, v168, v184
    v_cvt_pk_bf16_f32 v198, v140, v156
    v_cvt_pk_bf16_f32 v199, v172, v188
    buffer_store_dwordx4 v[196:199], v4, s[16:19], s46 offen offset:256 sc1
    v_cvt_pk_bf16_f32 v200, v129, v145
    v_cvt_pk_bf16_f32 v201, v161, v177
    v_cvt_pk_bf16_f32 v202, v133, v149
    v_cvt_pk_bf16_f32 v203, v165, v181
    buffer_store_dwordx4 v[200:203], v4, s[16:19], s46 offen offset:512 sc1
    v_cvt_pk_bf16_f32 v204, v137, v153
    v_cvt_pk_bf16_f32 v205, v169, v185
    v_cvt_pk_bf16_f32 v206, v141, v157
    v_cvt_pk_bf16_f32 v207, v173, v189
    buffer_store_dwordx4 v[204:207], v4, s[16:19], s46 offen offset:768 sc1
    v_cvt_pk_bf16_f32 v208, v130, v146
    v_cvt_pk_bf16_f32 v209, v162, v178
    v_cvt_pk_bf16_f32 v210, v134, v150
    v_cvt_pk_bf16_f32 v211, v166, v182
    buffer_store_dwordx4 v[208:211], v4, s[16:19], s47 offen offset:0 sc1
    v_cvt_pk_bf16_f32 v212, v138, v154
    v_cvt_pk_bf16_f32 v213, v170, v186
    v_cvt_pk_bf16_f32 v214, v142, v158
    v_cvt_pk_bf16_f32 v215, v174, v190
    buffer_store_dwordx4 v[212:215], v4, s[16:19], s47 offen offset:256 sc1
    v_cvt_pk_bf16_f32 v216, v131, v147
    v_cvt_pk_bf16_f32 v217, v163, v179
    v_cvt_pk_bf16_f32 v218, v135, v151
    v_cvt_pk_bf16_f32 v219, v167, v183
    buffer_store_dwordx4 v[216:219], v4, s[16:19], s47 offen offset:512 sc1
    v_cvt_pk_bf16_f32 v220, v139, v155
    v_cvt_pk_bf16_f32 v221, v171, v187
    v_cvt_pk_bf16_f32 v222, v143, v159
    v_cvt_pk_bf16_f32 v223, v175, v191
    buffer_store_dwordx4 v[220:223], v4, s[16:19], s47 offen offset:768 sc1
    v_and_b32 v7, 31, v1
    v_lshlrev_b32 v7, 3, v7
    buffer_load_dword v15, v7, s[28:31], 0 offen sc1
    s_setprio 0
    v_and_b32 v5, 31, v1
    s_lshl_b32 s49, s33, 6
    s_add_u32 s49, s49, 2
    s_sub_u32 s49, s49, s34
    v_lshl_add_u32 v5, v5, 1, s49
    v_cvt_f32_u32 v5, v5
    v_mul_f32 v5, 0x3b124925, v5
    v_lshrrev_b32 v4, 5, v1
    v_cvt_f32_u32 v6, v4
    v_mul_f32 v8, 4.0, v5
    v_fma_f32 v6, v6, 2.0, 0.5
    v_cos_f32 v8, v8
    v_mul_f32 v6, v6, v5
    v_add_f32 v8, v8, v8
    v_mov_b32 v130, v6
    v_fmamk_f32 v131, v5, 0x3f800000, v6
    v_cos_f32 v128, v130
    v_cos_f32 v129, v131
    v_sin_f32 v130, v130
    v_sin_f32 v131, v131
    v_fmamk_f32 v134, v5, 0x40800000, v6
    v_fmamk_f32 v135, v5, 0x40a00000, v6
    v_cos_f32 v132, v134
    v_cos_f32 v133, v135
    v_sin_f32 v134, v134
    v_sin_f32 v135, v135
    v_pk_fma_f32 v[136:137], v[132:133], v[8:9], v[128:129] op_sel_hi:[1,0,1] neg_lo:[0,0,1] neg_hi:[0,0,1]
    v_pk_fma_f32 v[138:139], v[134:135], v[8:9], v[130:131] op_sel_hi:[1,0,1] neg_lo:[0,0,1] neg_hi:[0,0,1]
    v_pk_fma_f32 v[140:141], v[136:137], v[8:9], v[132:133] op_sel_hi:[1,0,1] neg_lo:[0,0,1] neg_hi:[0,0,1]
    v_pk_fma_f32 v[142:143], v[138:139], v[8:9], v[134:135] op_sel_hi:[1,0,1] neg_lo:[0,0,1] neg_hi:[0,0,1]
    v_pk_fma_f32 v[144:145], v[140:141], v[8:9], v[136:137] op_sel_hi:[1,0,1] neg_lo:[0,0,1] neg_hi:[0,0,1]
    v_pk_fma_f32 v[146:147], v[142:143], v[8:9], v[138:139] op_sel_hi:[1,0,1] neg_lo:[0,0,1] neg_hi:[0,0,1]
    v_pk_fma_f32 v[148:149], v[144:145], v[8:9], v[140:141] op_sel_hi:[1,0,1] neg_lo:[0,0,1] neg_hi:[0,0,1]
    v_pk_fma_f32 v[150:151], v[146:147], v[8:9], v[142:143] op_sel_hi:[1,0,1] neg_lo:[0,0,1] neg_hi:[0,0,1]
    v_cvt_pk_bf16_f32 v72, v128, v144
    v_cvt_pk_bf16_f32 v74, v129, v145
    v_cvt_pk_bf16_f32 v76, v130, v146
    v_cvt_pk_bf16_f32 v78, v131, v147
    v_pk_fma_f32 v[152:153], v[148:149], v[8:9], v[144:145] op_sel_hi:[1,0,1] neg_lo:[0,0,1] neg_hi:[0,0,1]
    v_pk_fma_f32 v[154:155], v[150:151], v[8:9], v[146:147] op_sel_hi:[1,0,1] neg_lo:[0,0,1] neg_hi:[0,0,1]
    v_cvt_pk_bf16_f32 v80, v132, v148
    v_cvt_pk_bf16_f32 v82, v133, v149
    v_cvt_pk_bf16_f32 v84, v134, v150
    v_cvt_pk_bf16_f32 v86, v135, v151
    v_pk_fma_f32 v[156:157], v[152:153], v[8:9], v[148:149] op_sel_hi:[1,0,1] neg_lo:[0,0,1] neg_hi:[0,0,1]
    v_pk_fma_f32 v[158:159], v[154:155], v[8:9], v[150:151] op_sel_hi:[1,0,1] neg_lo:[0,0,1] neg_hi:[0,0,1]
    v_cvt_pk_bf16_f32 v88, v136, v152
    v_cvt_pk_bf16_f32 v90, v137, v153
    v_cvt_pk_bf16_f32 v92, v138, v154
    v_cvt_pk_bf16_f32 v94, v139, v155
    v_pk_fma_f32 v[128:129], v[156:157], v[8:9], v[152:153] op_sel_hi:[1,0,1] neg_lo:[0,0,1] neg_hi:[0,0,1]
    v_pk_fma_f32 v[130:131], v[158:159], v[8:9], v[154:155] op_sel_hi:[1,0,1] neg_lo:[0,0,1] neg_hi:[0,0,1]
    v_cvt_pk_bf16_f32 v96, v140, v156
    v_cvt_pk_bf16_f32 v98, v141, v157
    v_cvt_pk_bf16_f32 v100, v142, v158
    v_cvt_pk_bf16_f32 v102, v143, v159
    v_pk_fma_f32 v[132:133], v[128:129], v[8:9], v[156:157] op_sel_hi:[1,0,1] neg_lo:[0,0,1] neg_hi:[0,0,1]
    v_pk_fma_f32 v[134:135], v[130:131], v[8:9], v[158:159] op_sel_hi:[1,0,1] neg_lo:[0,0,1] neg_hi:[0,0,1]
    v_pk_fma_f32 v[136:137], v[132:133], v[8:9], v[128:129] op_sel_hi:[1,0,1] neg_lo:[0,0,1] neg_hi:[0,0,1]
    v_pk_fma_f32 v[138:139], v[134:135], v[8:9], v[130:131] op_sel_hi:[1,0,1] neg_lo:[0,0,1] neg_hi:[0,0,1]
    v_pk_fma_f32 v[140:141], v[136:137], v[8:9], v[132:133] op_sel_hi:[1,0,1] neg_lo:[0,0,1] neg_hi:[0,0,1]
    v_pk_fma_f32 v[142:143], v[138:139], v[8:9], v[134:135] op_sel_hi:[1,0,1] neg_lo:[0,0,1] neg_hi:[0,0,1]
    v_pk_fma_f32 v[144:145], v[140:141], v[8:9], v[136:137] op_sel_hi:[1,0,1] neg_lo:[0,0,1] neg_hi:[0,0,1]
    v_pk_fma_f32 v[146:147], v[142:143], v[8:9], v[138:139] op_sel_hi:[1,0,1] neg_lo:[0,0,1] neg_hi:[0,0,1]
    v_pk_fma_f32 v[148:149], v[144:145], v[8:9], v[140:141] op_sel_hi:[1,0,1] neg_lo:[0,0,1] neg_hi:[0,0,1]
    v_pk_fma_f32 v[150:151], v[146:147], v[8:9], v[142:143] op_sel_hi:[1,0,1] neg_lo:[0,0,1] neg_hi:[0,0,1]
    v_cvt_pk_bf16_f32 v73, v128, v144
    v_cvt_pk_bf16_f32 v75, v129, v145
    v_cvt_pk_bf16_f32 v77, v130, v146
    v_cvt_pk_bf16_f32 v79, v131, v147
    v_pk_fma_f32 v[152:153], v[148:149], v[8:9], v[144:145] op_sel_hi:[1,0,1] neg_lo:[0,0,1] neg_hi:[0,0,1]
    v_pk_fma_f32 v[154:155], v[150:151], v[8:9], v[146:147] op_sel_hi:[1,0,1] neg_lo:[0,0,1] neg_hi:[0,0,1]
    v_cvt_pk_bf16_f32 v81, v132, v148
    v_cvt_pk_bf16_f32 v83, v133, v149
    v_cvt_pk_bf16_f32 v85, v134, v150
    v_cvt_pk_bf16_f32 v87, v135, v151
    v_pk_fma_f32 v[156:157], v[152:153], v[8:9], v[148:149] op_sel_hi:[1,0,1] neg_lo:[0,0,1] neg_hi:[0,0,1]
    v_pk_fma_f32 v[158:159], v[154:155], v[8:9], v[150:151] op_sel_hi:[1,0,1] neg_lo:[0,0,1] neg_hi:[0,0,1]
    v_cvt_pk_bf16_f32 v89, v136, v152
    v_cvt_pk_bf16_f32 v91, v137, v153
    v_cvt_pk_bf16_f32 v93, v138, v154
    v_cvt_pk_bf16_f32 v95, v139, v155
    v_cvt_pk_bf16_f32 v97, v140, v156
    v_cvt_pk_bf16_f32 v99, v141, v157
    v_cvt_pk_bf16_f32 v101, v142, v158
    v_cvt_pk_bf16_f32 v103, v143, v159
    s_lshl_b32 s49, s3, 10
    s_add_u32 s49, s49, s37
    v_and_b32 v14, 3, v1
    v_lshlrev_b32 v14, 13, v14
    v_and_b32 v13, 4, v1
    v_lshl_add_u32 v14, v13, 10, v14
    s_lshl_b32 s50, s3, 15
    s_lshr_b32 s51, s2, 3
    s_lshl_b32 s51, s51, 10
    s_add_u32 s50, s50, s51
    s_add_u32 s50, s50, 12649344
    s_setprio 3
    s_waitcnt vmcnt(1)
    s_mov_b64 exec, 1
    buffer_store_dword v3, off, s[16:19], s49 offset:896 sc1
    s_mov_b64 exec, -1
    s_mov_b32 s99, 0
    s_waitcnt vmcnt(1)
    v_cmp_ne_u32 vcc, 1, v15
    s_nop 0
    s_and_b64 vcc, vcc, -1
    s_cbranch_scc0 SP8_D
    s_mov_b64 exec, -1
SP8:
    buffer_load_dword v15, v7, s[28:31], 0 offen sc1
    s_add_u32 s99, s99, 1
    s_waitcnt vmcnt(0)
    v_cmp_ne_u32 vcc, 1, v15
    s_nop 1
    s_cmp_eq_u64 vcc, 0
    s_cbranch_scc1 SP8_E
    s_cmp_lt_u32 s99, 131072
    s_cbranch_scc1 SP8
SP8_E:
    s_mov_b64 exec, -1
SP8_D:
    s_barrier
    s_setprio 0
    v_fmamk_f32 v130, v5, 0x42800000, v6
    v_fmamk_f32 v131, v5, 0x42820000, v6
    v_cos_f32 v128, v130
    v_cos_f32 v129, v131
    v_sin_f32 v130, v130
    v_sin_f32 v131, v131
    v_fmamk_f32 v134, v5, 0x42880000, v6
    v_fmamk_f32 v135, v5, 0x428a0000, v6
    v_cos_f32 v132, v134
    v_cos_f32 v133, v135
    v_sin_f32 v134, v134
    v_sin_f32 v135, v135
    v_pk_fma_f32 v[136:137], v[132:133], v[8:9], v[128:129] op_sel_hi:[1,0,1] neg_lo:[0,0,1] neg_hi:[0,0,1]
    v_pk_fma_f32 v[138:139], v[134:135], v[8:9], v[130:131] op_sel_hi:[1,0,1] neg_lo:[0,0,1] neg_hi:[0,0,1]
    v_pk_fma_f32 v[140:141], v[136:137], v[8:9], v[132:133] op_sel_hi:[1,0,1] neg_lo:[0,0,1] neg_hi:[0,0,1]
    v_pk_fma_f32 v[142:143], v[138:139], v[8:9], v[134:135] op_sel_hi:[1,0,1] neg_lo:[0,0,1] neg_hi:[0,0,1]
    v_pk_fma_f32 v[144:145], v[140:141], v[8:9], v[136:137] op_sel_hi:[1,0,1] neg_lo:[0,0,1] neg_hi:[0,0,1]
    v_pk_fma_f32 v[146:147], v[142:143], v[8:9], v[138:139] op_sel_hi:[1,0,1] neg_lo:[0,0,1] neg_hi:[0,0,1]
    v_cvt_pk_bf16_f32 v104, v128, v140
    v_cvt_pk_bf16_f32 v106, v129, v141
    v_cvt_pk_bf16_f32 v108, v130, v142
    v_cvt_pk_bf16_f32 v110, v131, v143
    v_pk_fma_f32 v[148:149], v[144:145], v[8:9], v[140:141] op_sel_hi:[1,0,1] neg_lo:[0,0,1] neg_hi:[0,0,1]
    v_pk_fma_f32 v[150:151], v[146:147], v[8:9], v[142:143] op_sel_hi:[1,0,1] neg_lo:[0,0,1] neg_hi:[0,0,1]
    v_cvt_pk_bf16_f32 v112, v132, v144
    v_cvt_pk_bf16_f32 v114, v133, v145
    v_cvt_pk_bf16_f32 v116, v134, v146
    v_cvt_pk_bf16_f32 v118, v135, v147
    v_pk_fma_f32 v[152:153], v[148:149], v[8:9], v[144:145] op_sel_hi:[1,0,1] neg_lo:[0,0,1] neg_hi:[0,0,1]
    v_pk_fma_f32 v[154:155], v[150:151], v[8:9], v[146:147] op_sel_hi:[1,0,1] neg_lo:[0,0,1] neg_hi:[0,0,1]
    v_cvt_pk_bf16_f32 v120, v136, v148
    v_cvt_pk_bf16_f32 v122, v137, v149
    v_cvt_pk_bf16_f32 v124, v138, v150
    v_cvt_pk_bf16_f32 v126, v139, v151
    v_pk_fma_f32 v[156:157], v[152:153], v[8:9], v[148:149] op_sel_hi:[1,0,1] neg_lo:[0,0,1] neg_hi:[0,0,1]
    v_pk_fma_f32 v[158:159], v[154:155], v[8:9], v[150:151] op_sel_hi:[1,0,1] neg_lo:[0,0,1] neg_hi:[0,0,1]
    v_pk_fma_f32 v[128:129], v[156:157], v[8:9], v[152:153] op_sel_hi:[1,0,1] neg_lo:[0,0,1] neg_hi:[0,0,1]
    v_pk_fma_f32 v[130:131], v[158:159], v[8:9], v[154:155] op_sel_hi:[1,0,1] neg_lo:[0,0,1] neg_hi:[0,0,1]
    v_pk_fma_f32 v[132:133], v[128:129], v[8:9], v[156:157] op_sel_hi:[1,0,1] neg_lo:[0,0,1] neg_hi:[0,0,1]
    v_pk_fma_f32 v[134:135], v[130:131], v[8:9], v[158:159] op_sel_hi:[1,0,1] neg_lo:[0,0,1] neg_hi:[0,0,1]
    v_pk_fma_f32 v[136:137], v[132:133], v[8:9], v[128:129] op_sel_hi:[1,0,1] neg_lo:[0,0,1] neg_hi:[0,0,1]
    v_pk_fma_f32 v[138:139], v[134:135], v[8:9], v[130:131] op_sel_hi:[1,0,1] neg_lo:[0,0,1] neg_hi:[0,0,1]
    v_cvt_pk_bf16_f32 v105, v152, v132
    v_cvt_pk_bf16_f32 v107, v153, v133
    v_cvt_pk_bf16_f32 v109, v154, v134
    v_cvt_pk_bf16_f32 v111, v155, v135
    v_pk_fma_f32 v[140:141], v[136:137], v[8:9], v[132:133] op_sel_hi:[1,0,1] neg_lo:[0,0,1] neg_hi:[0,0,1]
    v_pk_fma_f32 v[142:143], v[138:139], v[8:9], v[134:135] op_sel_hi:[1,0,1] neg_lo:[0,0,1] neg_hi:[0,0,1]
    v_cvt_pk_bf16_f32 v113, v156, v136
    v_cvt_pk_bf16_f32 v115, v157, v137
    v_cvt_pk_bf16_f32 v117, v158, v138
    v_cvt_pk_bf16_f32 v119, v159, v139
    v_cvt_pk_bf16_f32 v121, v128, v140
    v_cvt_pk_bf16_f32 v123, v129, v141
    v_cvt_pk_bf16_f32 v125, v130, v142
    v_cvt_pk_bf16_f32 v127, v131, v143
    s_lshl_b32 s51, s2, 16
    s_lshl_b32 s49, s3, 13
    s_add_u32 s51, s51, s49
    s_add_u32 s51, s51, 8388608
    s_mul_i32 s52, s3, 4128
    v_and_b32 v5, 31, v1
    s_lshl_b32 s49, s33, 5
    v_add_u32 v5, s49, v5
    v_cvt_f32_u32 v6, v5
    v_add_f32 v6, 0.5, v6
    v_mul_f32 v6, 0x3b124925, v6
    s_sub_u32 s49, 2, s34
    v_lshl_add_u32 v7, v4, 3, s49
    v_mul_f32 v8, 0x41800000, v6
    v_cmp_eq_u32 vcc, 10, v7
    v_cvt_f32_u32 v7, v7
    v_cos_f32 v8, v8
    v_mul_f32 v7, v7, v6
    v_cndmask_b32 v192, 1.0, 0.5, vcc
    v_add_f32 v8, v8, v8
    v_mov_b32 v132, v7
    v_fmamk_f32 v133, v6, 0x40000000, v7
    v_fmamk_f32 v134, v6, 0x40800000, v7
    v_fmamk_f32 v135, v6, 0x40c00000, v7
    v_cos_f32 v128, v132
    v_cos_f32 v129, v133
    v_cos_f32 v130, v134
    v_cos_f32 v131, v135
    v_sin_f32 v132, v132
    v_sin_f32 v133, v133
    v_sin_f32 v134, v134
    v_sin_f32 v135, v135
    v_fmamk_f32 v140, v6, 0x41800000, v7
    v_fmamk_f32 v141, v6, 0x41900000, v7
    v_fmamk_f32 v142, v6, 0x41a00000, v7
    v_fmamk_f32 v143, v6, 0x41b00000, v7
    v_cos_f32 v136, v140
    v_cos_f32 v137, v141
    v_cos_f32 v138, v142
    v_cos_f32 v139, v143
    v_sin_f32 v140, v140
    v_sin_f32 v141, v141
    v_sin_f32 v142, v142
    v_sin_f32 v143, v143
    v_cvt_pk_bf16_f32 v16, v128, v129
    v_cvt_pk_bf16_f32 v17, v130, v131
    v_cvt_pk_bf16_f32 v20, v132, v133
    v_cvt_pk_bf16_f32 v21, v134, v135
    v_pk_fma_f32 v[144:145], v[136:137], v[8:9], v[128:129] op_sel_hi:[1,0,1] neg_lo:[0,0,1] neg_hi:[0,0,1]
    v_pk_fma_f32 v[146:147], v[138:139], v[8:9], v[130:131] op_sel_hi:[1,0,1] neg_lo:[0,0,1] neg_hi:[0,0,1]
    v_pk_fma_f32 v[148:149], v[140:141], v[8:9], v[132:133] op_sel_hi:[1,0,1] neg_lo:[0,0,1] neg_hi:[0,0,1]
    v_pk_fma_f32 v[150:151], v[142:143], v[8:9], v[134:135] op_sel_hi:[1,0,1] neg_lo:[0,0,1] neg_hi:[0,0,1]
    v_cvt_pk_bf16_f32 v18, v136, v137
    v_cvt_pk_bf16_f32 v19, v138, v139
    v_cvt_pk_bf16_f32 v22, v140, v141
    v_cvt_pk_bf16_f32 v23, v142, v143
    s_cmp_lg_u32 s34, 1
    s_cbranch_scc1 V1G1
    s_setprio 3
    s_mov_b32 s99, 0
    s_mov_b64 exec, 0xff
SP9:
    buffer_load_dword v15, v14, s[16:19], s50 offen sc1
    s_add_u32 s99, s99, 1
    s_waitcnt vmcnt(0)
    v_cmp_ne_u32 vcc, 1, v15
    s_nop 1
    s_cmp_eq_u64 vcc, 0
    s_cbranch_scc1 SP9_E
    s_cmp_lt_u32 s99, 131072
    s_cbranch_scc1 SP9
SP9_E:
    s_mov_b64 exec, -1
SP9_D:
    s_add_u32 m0, s52, 0
    s_add_u32 s49, s51, 0
    buffer_load_dwordx4 v2, s[16:19], s49 offen sc1 lds
    s_add_u32 m0, s52, 1032
    s_add_u32 s49, s51, 2048
    buffer_load_dwordx4 v2, s[16:19], s49 offen sc1 lds
    s_add_u32 m0, s52, 2064
    s_add_u32 s49, s51, 4096
    buffer_load_dwordx4 v2, s[16:19], s49 offen sc1 lds
    s_add_u32 m0, s52, 3096
    s_add_u32 s49, s51, 6144
    buffer_load_dwordx4 v2, s[16:19], s49 offen sc1 lds
    s_add_u32 m0, s52, 33024
    s_add_u32 s49, s51, 1024
    buffer_load_dwordx4 v2, s[16:19], s49 offen sc1 lds
    s_add_u32 m0, s52, 34056
    s_add_u32 s49, s51, 3072
    buffer_load_dwordx4 v2, s[16:19], s49 offen sc1 lds
    s_add_u32 m0, s52, 35088
    s_add_u32 s49, s51, 5120
    buffer_load_dwordx4 v2, s[16:19], s49 offen sc1 lds
    s_add_u32 m0, s52, 36120
    s_add_u32 s49, s51, 7168
    buffer_load_dwordx4 v2, s[16:19], s49 offen sc1 lds
    s_setprio 0
V1G1:
    v_pk_fma_f32 v[152:153], v[144:145], v[8:9], v[136:137] op_sel_hi:[1,0,1] neg_lo:[0,0,1] neg_hi:[0,0,1]
    v_pk_fma_f32 v[154:155], v[146:147], v[8:9], v[138:139] op_sel_hi:[1,0,1] neg_lo:[0,0,1] neg_hi:[0,0,1]
    v_pk_fma_f32 v[156:157], v[148:149], v[8:9], v[140:141] op_sel_hi:[1,0,1] neg_lo:[0,0,1] neg_hi:[0,0,1]
    v_pk_fma_f32 v[158:159], v[150:151], v[8:9], v[142:143] op_sel_hi:[1,0,1] neg_lo:[0,0,1] neg_hi:[0,0,1]
    v_cvt_pk_bf16_f32 v24, v144, v145
    v_cvt_pk_bf16_f32 v25, v146, v147
    v_cvt_pk_bf16_f32 v28, v148, v149
    v_cvt_pk_bf16_f32 v29, v150, v151
    v_pk_fma_f32 v[128:129], v[152:153], v[8:9], v[144:145] op_sel_hi:[1,0,1] neg_lo:[0,0,1] neg_hi:[0,0,1]
    v_pk_fma_f32 v[130:131], v[154:155], v[8:9], v[146:147] op_sel_hi:[1,0,1] neg_lo:[0,0,1] neg_hi:[0,0,1]
    v_pk_fma_f32 v[132:133], v[156:157], v[8:9], v[148:149] op_sel_hi:[1,0,1] neg_lo:[0,0,1] neg_hi:[0,0,1]
    v_pk_fma_f32 v[134:135], v[158:159], v[8:9], v[150:151] op_sel_hi:[1,0,1] neg_lo:[0,0,1] neg_hi:[0,0,1]
    v_cvt_pk_bf16_f32 v26, v152, v153
    v_cvt_pk_bf16_f32 v27, v154, v155
    v_cvt_pk_bf16_f32 v30, v156, v157
    v_cvt_pk_bf16_f32 v31, v158, v159
    buffer_load_dword v15, v14, s[16:19], s50 offen sc1
    v_pk_fma_f32 v[136:137], v[128:129], v[8:9], v[152:153] op_sel_hi:[1,0,1] neg_lo:[0,0,1] neg_hi:[0,0,1]
    v_pk_fma_f32 v[138:139], v[130:131], v[8:9], v[154:155] op_sel_hi:[1,0,1] neg_lo:[0,0,1] neg_hi:[0,0,1]
    v_pk_fma_f32 v[140:141], v[132:133], v[8:9], v[156:157] op_sel_hi:[1,0,1] neg_lo:[0,0,1] neg_hi:[0,0,1]
    v_pk_fma_f32 v[142:143], v[134:135], v[8:9], v[158:159] op_sel_hi:[1,0,1] neg_lo:[0,0,1] neg_hi:[0,0,1]
    v_cvt_pk_bf16_f32 v32, v128, v129
    v_cvt_pk_bf16_f32 v33, v130, v131
    v_cvt_pk_bf16_f32 v36, v132, v133
    v_cvt_pk_bf16_f32 v37, v134, v135
    v_pk_fma_f32 v[144:145], v[136:137], v[8:9], v[128:129] op_sel_hi:[1,0,1] neg_lo:[0,0,1] neg_hi:[0,0,1]
    v_pk_fma_f32 v[146:147], v[138:139], v[8:9], v[130:131] op_sel_hi:[1,0,1] neg_lo:[0,0,1] neg_hi:[0,0,1]
    v_pk_fma_f32 v[148:149], v[140:141], v[8:9], v[132:133] op_sel_hi:[1,0,1] neg_lo:[0,0,1] neg_hi:[0,0,1]
    v_pk_fma_f32 v[150:151], v[142:143], v[8:9], v[134:135] op_sel_hi:[1,0,1] neg_lo:[0,0,1] neg_hi:[0,0,1]
    v_cvt_pk_bf16_f32 v34, v136, v137
    v_cvt_pk_bf16_f32 v35, v138, v139
    v_cvt_pk_bf16_f32 v38, v140, v141
    v_cvt_pk_bf16_f32 v39, v142, v143
    v_pk_fma_f32 v[152:153], v[144:145], v[8:9], v[136:137] op_sel_hi:[1,0,1] neg_lo:[0,0,1] neg_hi:[0,0,1]
    v_pk_fma_f32 v[154:155], v[146:147], v[8:9], v[138:139] op_sel_hi:[1,0,1] neg_lo:[0,0,1] neg_hi:[0,0,1]
    v_pk_fma_f32 v[156:157], v[148:149], v[8:9], v[140:141] op_sel_hi:[1,0,1] neg_lo:[0,0,1] neg_hi:[0,0,1]
    v_pk_fma_f32 v[158:159], v[150:151], v[8:9], v[142:143] op_sel_hi:[1,0,1] neg_lo:[0,0,1] neg_hi:[0,0,1]
    v_cvt_pk_bf16_f32 v40, v144, v145
    v_cvt_pk_bf16_f32 v41, v146, v147
    v_cvt_pk_bf16_f32 v44, v148, v149
    v_cvt_pk_bf16_f32 v45, v150, v151
    v_pk_fma_f32 v[128:129], v[152:153], v[8:9], v[144:145] op_sel_hi:[1,0,1] neg_lo:[0,0,1] neg_hi:[0,0,1]
    v_pk_fma_f32 v[130:131], v[154:155], v[8:9], v[146:147] op_sel_hi:[1,0,1] neg_lo:[0,0,1] neg_hi:[0,0,1]
    v_pk_fma_f32 v[132:133], v[156:157], v[8:9], v[148:149] op_sel_hi:[1,0,1] neg_lo:[0,0,1] neg_hi:[0,0,1]
    v_pk_fma_f32 v[134:135], v[158:159], v[8:9], v[150:151] op_sel_hi:[1,0,1] neg_lo:[0,0,1] neg_hi:[0,0,1]
    v_cvt_pk_bf16_f32 v42, v152, v153
    v_cvt_pk_bf16_f32 v43, v154, v155
    v_cvt_pk_bf16_f32 v46, v156, v157
    v_cvt_pk_bf16_f32 v47, v158, v159
    v_pk_fma_f32 v[136:137], v[128:129], v[8:9], v[152:153] op_sel_hi:[1,0,1] neg_lo:[0,0,1] neg_hi:[0,0,1]
    v_pk_fma_f32 v[138:139], v[130:131], v[8:9], v[154:155] op_sel_hi:[1,0,1] neg_lo:[0,0,1] neg_hi:[0,0,1]
    v_pk_fma_f32 v[140:141], v[132:133], v[8:9], v[156:157] op_sel_hi:[1,0,1] neg_lo:[0,0,1] neg_hi:[0,0,1]
    v_pk_fma_f32 v[142:143], v[134:135], v[8:9], v[158:159] op_sel_hi:[1,0,1] neg_lo:[0,0,1] neg_hi:[0,0,1]
    v_cvt_pk_bf16_f32 v48, v128, v129
    v_cvt_pk_bf16_f32 v49, v130, v131
    v_cvt_pk_bf16_f32 v52, v132, v133
    v_cvt_pk_bf16_f32 v53, v134, v135
    v_pk_fma_f32 v[144:145], v[136:137], v[8:9], v[128:129] op_sel_hi:[1,0,1] neg_lo:[0,0,1] neg_hi:[0,0,1]
    v_pk_fma_f32 v[146:147], v[138:139], v[8:9], v[130:131] op_sel_hi:[1,0,1] neg_lo:[0,0,1] neg_hi:[0,0,1]
    v_pk_fma_f32 v[148:149], v[140:141], v[8:9], v[132:133] op_sel_hi:[1,0,1] neg_lo:[0,0,1] neg_hi:[0,0,1]
    v_pk_fma_f32 v[150:151], v[142:143], v[8:9], v[134:135] op_sel_hi:[1,0,1] neg_lo:[0,0,1] neg_hi:[0,0,1]
    v_cvt_pk_bf16_f32 v50, v136, v137
    v_cvt_pk_bf16_f32 v51, v138, v139
    v_cvt_pk_bf16_f32 v54, v140, v141
    v_cvt_pk_bf16_f32 v55, v142, v143
    s_cmp_lg_u32 s34, 0
    s_cbranch_scc1 V1G0
    s_setprio 3
    s_mov_b32 s99, 0
    s_waitcnt vmcnt(0)
    v_cmp_ne_u32 vcc, 1, v15
    s_nop 0
    s_and_b64 vcc, vcc, 0xff
    s_cbranch_scc0 SP10_D
    s_mov_b64 exec, 0xff
SP10:
    buffer_load_dword v15, v14, s[16:19], s50 offen sc1
    s_add_u32 s99, s99, 1
    s_waitcnt vmcnt(0)
    v_cmp_ne_u32 vcc, 1, v15
    s_nop 1
    s_cmp_eq_u64 vcc, 0
    s_cbranch_scc1 SP10_E
    s_cmp_lt_u32 s99, 131072
    s_cbranch_scc1 SP10
SP10_E:
    s_mov_b64 exec, -1
SP10_D:
    s_add_u32 m0, s52, 0
    s_add_u32 s49, s51, 0
    buffer_load_dwordx4 v2, s[16:19], s49 offen sc1 lds
    s_add_u32 m0, s52, 1032
    s_add_u32 s49, s51, 2048
    buffer_load_dwordx4 v2, s[16:19], s49 offen sc1 lds
    s_add_u32 m0, s52, 2064
    s_add_u32 s49, s51, 4096
    buffer_load_dwordx4 v2, s[16:19], s49 offen sc1 lds
    s_add_u32 m0, s52, 3096
    s_add_u32 s49, s51, 6144
    buffer_load_dwordx4 v2, s[16:19], s49 offen sc1 lds
    s_add_u32 m0, s52, 33024
    s_add_u32 s49, s51, 1024
    buffer_load_dwordx4 v2, s[16:19], s49 offen sc1 lds
    s_add_u32 m0, s52, 34056
    s_add_u32 s49, s51, 3072
    buffer_load_dwordx4 v2, s[16:19], s49 offen sc1 lds
    s_add_u32 m0, s52, 35088
    s_add_u32 s49, s51, 5120
    buffer_load_dwordx4 v2, s[16:19], s49 offen sc1 lds
    s_add_u32 m0, s52, 36120
    s_add_u32 s49, s51, 7168
    buffer_load_dwordx4 v2, s[16:19], s49 offen sc1 lds
    s_setprio 0
V1G0:
    v_pk_fma_f32 v[152:153], v[144:145], v[8:9], v[136:137] op_sel_hi:[1,0,1] neg_lo:[0,0,1] neg_hi:[0,0,1]
    v_pk_fma_f32 v[154:155], v[146:147], v[8:9], v[138:139] op_sel_hi:[1,0,1] neg_lo:[0,0,1] neg_hi:[0,0,1]
    v_pk_fma_f32 v[156:157], v[148:149], v[8:9], v[140:141] op_sel_hi:[1,0,1] neg_lo:[0,0,1] neg_hi:[0,0,1]
    v_pk_fma_f32 v[158:159], v[150:151], v[8:9], v[142:143] op_sel_hi:[1,0,1] neg_lo:[0,0,1] neg_hi:[0,0,1]
    v_cvt_pk_bf16_f32 v56, v144, v145
    v_cvt_pk_bf16_f32 v57, v146, v147
    v_cvt_pk_bf16_f32 v60, v148, v149
    v_cvt_pk_bf16_f32 v61, v150, v151
    v_pk_fma_f32 v[128:129], v[152:153], v[8:9], v[144:145] op_sel_hi:[1,0,1] neg_lo:[0,0,1] neg_hi:[0,0,1]
    v_pk_fma_f32 v[130:131], v[154:155], v[8:9], v[146:147] op_sel_hi:[1,0,1] neg_lo:[0,0,1] neg_hi:[0,0,1]
    v_pk_fma_f32 v[132:133], v[156:157], v[8:9], v[148:149] op_sel_hi:[1,0,1] neg_lo:[0,0,1] neg_hi:[0,0,1]
    v_pk_fma_f32 v[134:135], v[158:159], v[8:9], v[150:151] op_sel_hi:[1,0,1] neg_lo:[0,0,1] neg_hi:[0,0,1]
    v_cvt_pk_bf16_f32 v58, v152, v153
    v_cvt_pk_bf16_f32 v59, v154, v155
    v_cvt_pk_bf16_f32 v62, v156, v157
    v_cvt_pk_bf16_f32 v63, v158, v159
    v_pk_fma_f32 v[136:137], v[128:129], v[8:9], v[152:153] op_sel_hi:[1,0,1] neg_lo:[0,0,1] neg_hi:[0,0,1]
    v_pk_fma_f32 v[138:139], v[130:131], v[8:9], v[154:155] op_sel_hi:[1,0,1] neg_lo:[0,0,1] neg_hi:[0,0,1]
    v_pk_fma_f32 v[140:141], v[132:133], v[8:9], v[156:157] op_sel_hi:[1,0,1] neg_lo:[0,0,1] neg_hi:[0,0,1]
    v_pk_fma_f32 v[142:143], v[134:135], v[8:9], v[158:159] op_sel_hi:[1,0,1] neg_lo:[0,0,1] neg_hi:[0,0,1]
    v_cvt_pk_bf16_f32 v64, v128, v129
    v_cvt_pk_bf16_f32 v65, v130, v131
    v_cvt_pk_bf16_f32 v68, v132, v133
    v_cvt_pk_bf16_f32 v69, v134, v135
    v_mul_f32 v143, v143, v192
    v_and_b32 v6, 31, v1
    v_mul_u32_u24 v9, 1032, v6
    v_lshl_add_u32 v9, v4, 5, v9
    s_lshl_b32 s49, s34, 8
    v_add_u32 v9, s49, v9
    v_lshlrev_b32 v13, 2, v5
    s_lshl_b32 s49, s34, 1
    s_sub_u32 s49, 66564, s49
    v_lshl_add_u32 v10, v4, 13, s49
    v_add_u32 v10, v10, v13
    s_lshl_b32 s49, s2, 1
    s_sub_u32 s54, 64, s49
    s_and_b32 s54, s54, 63
    v_add_u32 v8, s54, v10
    v_add_u32 v10, s49, v10
    v_lshl_add_u32 v13, v4, 18, v13
    s_lshl_b32 s49, s34, 15
    v_add_u32 v12, s49, v2
    s_lshl_b32 s49, s33, 11
    v_add_u32 v11, s49, v12
    v_add_u32 v14, 132096, v2
    s_lshl_b32 s53, s2, 11
    s_lshl_b32 s49, s34, 10
    s_add_u32 s53, s53, s49
    s_add_u32 s53, s53, 10485760
    v_cvt_pk_bf16_f32 v66, v136, v137
    v_cvt_pk_bf16_f32 v67, v138, v139
    v_cvt_pk_bf16_f32 v70, v140, v141
    v_cvt_pk_bf16_f32 v71, v142, v143
    ds_read_b128 v[224:227], v14 offset:0
    ds_read_b128 v[228:231], v14 offset:1024
    ds_read_b128 v[232:235], v14 offset:2048
    ds_read_b128 v[236:239], v14 offset:3072
    ds_read_b128 v[240:243], v14 offset:4096
    ds_read_b128 v[244:247], v14 offset:5120
    ds_read_b128 v[248:251], v14 offset:6144
    ds_read_b128 v[252:255], v14 offset:7168
    s_mov_b64 exec, 0
    s_cmp_eq_u32 s3, 0
    s_cbranch_scc1 PADS0
    s_cmp_eq_u32 s3, 1
    s_cbranch_scc1 PADS9
    s_cmp_eq_u32 s3, 2
    s_cbranch_scc1 PADS19
    s_cmp_eq_u32 s3, 3
    s_cbranch_scc1 PADS29
RETS:
    s_mov_b64 exec, -1
    s_waitcnt vmcnt(4)
    s_barrier
    s_cmp_lg_u32 s34, 1
    s_cbranch_scc1 RB11
    s_waitcnt vmcnt(0)
    s_barrier
RB11:
    ds_read_b64 v[192:193], v9 offset:0
    ds_read_b64 v[194:195], v9 offset:16
    ds_read_b64 v[196:197], v9 offset:512
    ds_read_b64 v[198:199], v9 offset:528
    ds_read_b64 v[200:201], v9 offset:8
    ds_read_b64 v[202:203], v9 offset:24
    ds_read_b64 v[204:205], v9 offset:520
    ds_read_b64 v[206:207], v9 offset:536
    s_waitcnt lgkmcnt(6)
    v_mfma_f32_32x32x16_bf16 v[128:143], v[192:195], v[72:75], 0
    ds_read_b64 v[208:209], v9 offset:64
    ds_read_b64 v[210:211], v9 offset:80
    ds_read_b64 v[212:213], v9 offset:576
    s_waitcnt lgkmcnt(7)
    v_mfma_f32_32x32x16_bf16 v[144:159], v[196:199], v[72:75], 0
    ds_read_b64 v[214:215], v9 offset:592
    ds_read_b64 v[216:217], v9 offset:72
    ds_read_b64 v[218:219], v9 offset:88
    s_waitcnt lgkmcnt(8)
    v_mfma_f32_32x32x16_bf16 v[160:175], v[200:203], v[76:79], 0
    ds_read_b64 v[220:221], v9 offset:584
    ds_read_b64 v[222:223], v9 offset:600
    s_waitcnt lgkmcnt(8)
    v_mfma_f32_32x32x16_bf16 v[176:191], v[204:207], v[76:79], 0
    s_waitcnt lgkmcnt(6)
    v_mfma_f32_32x32x16_bf16 v[128:143], v[208:211], v[80:83], v[128:143]
    s_waitcnt vmcnt(0)
    s_cmp_lg_u32 s34, 0
    s_cbranch_scc1 RB12
    s_barrier
RB12:
    ds_read_b64 v[192:193], v9 offset:128
    ds_read_b64 v[194:195], v9 offset:144
    s_waitcnt lgkmcnt(6)
    v_mfma_f32_32x32x16_bf16 v[144:159], v[212:215], v[80:83], v[144:159]
    ds_read_b64 v[196:197], v9 offset:640
    ds_read_b64 v[198:199], v9 offset:656
    ds_read_b64 v[200:201], v9 offset:136
    s_waitcnt lgkmcnt(7)
    v_mfma_f32_32x32x16_bf16 v[160:175], v[216:219], v[84:87], v[160:175]
    ds_read_b64 v[202:203], v9 offset:152
    ds_read_b64 v[204:205], v9 offset:648
    ds_read_b64 v[206:207], v9 offset:664
    s_waitcnt lgkmcnt(8)
    v_mfma_f32_32x32x16_bf16 v[176:191], v[220:223], v[84:87], v[176:191]
    s_waitcnt lgkmcnt(6)
    v_mfma_f32_32x32x16_bf16 v[128:143], v[192:195], v[88:91], v[128:143]
    ds_read_b64 v[208:209], v9 offset:192
    ds_read_b64 v[210:211], v9 offset:208
    ds_read_b64 v[212:213], v9 offset:704
    s_waitcnt lgkmcnt(7)
    v_mfma_f32_32x32x16_bf16 v[144:159], v[196:199], v[88:91], v[144:159]
    ds_read_b64 v[214:215], v9 offset:720
    ds_read_b64 v[216:217], v9 offset:200
    ds_read_b64 v[218:219], v9 offset:216
    s_waitcnt lgkmcnt(8)
    v_mfma_f32_32x32x16_bf16 v[160:175], v[200:203], v[92:95], v[160:175]
    ds_read_b64 v[220:221], v9 offset:712
    ds_read_b64 v[222:223], v9 offset:728
    s_waitcnt lgkmcnt(8)
    v_mfma_f32_32x32x16_bf16 v[176:191], v[204:207], v[92:95], v[176:191]
    s_waitcnt lgkmcnt(6)
    v_mfma_f32_32x32x16_bf16 v[128:143], v[208:211], v[96:99], v[128:143]
    ds_read_b64 v[192:193], v9 offset:33024
    ds_read_b64 v[194:195], v9 offset:33040
    ds_read_b64 v[196:197], v9 offset:33536
    s_waitcnt lgkmcnt(7)
    v_mfma_f32_32x32x16_bf16 v[144:159], v[212:215], v[96:99], v[144:159]
    ds_read_b64 v[198:199], v9 offset:33552
    ds_read_b64 v[200:201], v9 offset:33032
    ds_read_b64 v[202:203], v9 offset:33048
    s_waitcnt lgkmcnt(8)
    v_mfma_f32_32x32x16_bf16 v[160:175], v[216:219], v[100:103], v[160:175]
    ds_read_b64 v[204:205], v9 offset:33544
    ds_read_b64 v[206:207], v9 offset:33560
    s_waitcnt lgkmcnt(8)
    v_mfma_f32_32x32x16_bf16 v[176:191], v[220:223], v[100:103], v[176:191]
    s_waitcnt lgkmcnt(6)
    v_mfma_f32_32x32x16_bf16 v[128:143], v[192:195], v[104:107], v[128:143]
    ds_read_b64 v[208:209], v9 offset:33088
    ds_read_b64 v[210:211], v9 offset:33104
    ds_read_b64 v[212:213], v9 offset:33600
    s_waitcnt lgkmcnt(7)
    v_mfma_f32_32x32x16_bf16 v[144:159], v[196:199], v[104:107], v[144:159]
    ds_read_b64 v[214:215], v9 offset:33616
    ds_read_b64 v[216:217], v9 offset:33096
    ds_read_b64 v[218:219], v9 offset:33112
    s_waitcnt lgkmcnt(8)
    v_mfma_f32_32x32x16_bf16 v[160:175], v[200:203], v[108:111], v[160:175]
    ds_read_b64 v[220:221], v9 offset:33608
    ds_read_b64 v[222:223], v9 offset:33624
    s_waitcnt lgkmcnt(8)
    v_mfma_f32_32x32x16_bf16 v[176:191], v[204:207], v[108:111], v[176:191]
    s_waitcnt lgkmcnt(6)
    v_mfma_f32_32x32x16_bf16 v[128:143], v[208:211], v[112:115], v[128:143]
    ds_read_b64 v[192:193], v9 offset:33152
    ds_read_b64 v[194:195], v9 offset:33168
    ds_read_b64 v[196:197], v9 offset:33664
    s_waitcnt lgkmcnt(7)
    v_mfma_f32_32x32x16_bf16 v[144:159], v[212:215], v[112:115], v[144:159]
    ds_read_b64 v[198:199], v9 offset:33680
    ds_read_b64 v[200:201], v9 offset:33160
    ds_read_b64 v[202:203], v9 offset:33176
    s_waitcnt lgkmcnt(8)
    v_mfma_f32_32x32x16_bf16 v[160:175], v[216:219], v[116:119], v[160:175]
    ds_read_b64 v[204:205], v9 offset:33672
    ds_read_b64 v[206:207], v9 offset:33688
    s_waitcnt lgkmcnt(8)
    v_mfma_f32_32x32x16_bf16 v[176:191], v[220:223], v[116:119], v[176:191]
    s_waitcnt lgkmcnt(6)
    v_mfma_f32_32x32x16_bf16 v[128:143], v[192:195], v[120:123], v[128:143]
    s_waitcnt lgkmcnt(4)
    v_mfma_f32_32x32x16_bf16 v[144:159], v[196:199], v[120:123], v[144:159]
    s_waitcnt lgkmcnt(2)
    v_mfma_f32_32x32x16_bf16 v[160:175], v[200:203], v[124:127], v[160:175]
    s_waitcnt lgkmcnt(0)
    v_mfma_f32_32x32x16_bf16 v[176:191], v[204:207], v[124:127], v[176:191]
PADS0:
    s_cbranch_execz PADS1
    s_nop 5
    v_cvt_pk_bf16_f32 v208, v128, v129
    v_cvt_pk_bf16_f32 v209, v130, v131
    v_cvt_pk_bf16_f32 v210, v132, v133
    v_cvt_pk_bf16_f32 v211, v134, v135
    v_cvt_pk_bf16_f32 v212, v136, v137
    v_cvt_pk_bf16_f32 v213, v138, v139
    v_cvt_pk_bf16_f32 v214, v140, v141
    v_cvt_pk_bf16_f32 v215, v142, v143
PADS1:
    s_cbranch_execz PADS2
    v_cvt_pk_bf16_f32 v216, v144, v145
    v_cvt_pk_bf16_f32 v217, v146, v147
    v_cvt_pk_bf16_f32 v218, v148, v149
    v_cvt_pk_bf16_f32 v219, v150, v151
    v_cvt_pk_bf16_f32 v220, v152, v153
    v_cvt_pk_bf16_f32 v221, v154, v155
    v_cvt_pk_bf16_f32 v222, v156, v157
    v_cvt_pk_bf16_f32 v223, v158, v159
    v_mfma_f32_32x32x16_bf16 v[128:143], v[224:227], v[208:211], 0
    v_cvt_pk_bf16_f32 v192, v160, v161
    v_cvt_pk_bf16_f32 v193, v162, v163
    v_cvt_pk_bf16_f32 v194, v164, v165
    v_cvt_pk_bf16_f32 v195, v166, v167
    v_mfma_f32_32x32x16_bf16 v[144:159], v[248:251], v[208:211], 0
    v_cvt_pk_bf16_f32 v196, v168, v169
    v_cvt_pk_bf16_f32 v197, v170, v171
PADS2:
    s_cbranch_execz PADS3
    v_cvt_pk_bf16_f32 v198, v172, v173
    v_cvt_pk_bf16_f32 v199, v174, v175
    v_mfma_f32_32x32x16_bf16 v[128:143], v[228:231], v[212:215], v[128:143]
    v_cvt_pk_bf16_f32 v200, v176, v177
    v_cvt_pk_bf16_f32 v201, v178, v179
    v_cvt_pk_bf16_f32 v202, v180, v181
    v_cvt_pk_bf16_f32 v203, v182, v183
    v_mfma_f32_32x32x16_bf16 v[144:159], v[252:255], v[212:215], v[144:159]
    v_cvt_pk_bf16_f32 v204, v184, v185
    v_cvt_pk_bf16_f32 v205, v186, v187
    v_cvt_pk_bf16_f32 v206, v188, v189
    v_cvt_pk_bf16_f32 v207, v190, v191
    v_mfma_f32_32x32x16_bf16 v[128:143], v[232:235], v[216:219], v[128:143]
    ds_read_u16_d16_hi v72, v10 offset:0
    ds_read_u16_d16_hi v74, v10 offset:1024
PADS3:
    s_cbranch_execz PADS4
    ds_read_u16_d16_hi v76, v8 offset:512
    ds_read_u16_d16_hi v78, v8 offset:1536
    v_mfma_f32_32x32x16_bf16 v[144:159], v[240:243], v[216:219], v[144:159]
    ds_read_u16_d16_hi v73, v10 offset:2048
    ds_read_u16_d16_hi v75, v10 offset:3072
    ds_read_u16_d16_hi v77, v8 offset:2560
    ds_read_u16_d16_hi v79, v8 offset:3584
    v_mfma_f32_32x32x16_bf16 v[128:143], v[236:239], v[220:223], v[128:143]
    ds_read_u16_d16_hi v80, v10 offset:4096
    ds_read_u16_d16_hi v82, v10 offset:5120
    ds_read_u16_d16_hi v84, v8 offset:4608
    ds_read_u16_d16_hi v86, v8 offset:5632
    v_mfma_f32_32x32x16_bf16 v[144:159], v[244:247], v[220:223], v[144:159]
    ds_read_u16_d16_hi v81, v10 offset:6144
    ds_read_u16_d16_hi v83, v10 offset:7168
    ds_read_u16_d16_hi v85, v8 offset:6656
PADS4:
    s_cbranch_execz PADS5
    ds_read_u16_d16_hi v87, v8 offset:7680
    v_mfma_f32_32x32x16_bf16 v[160:175], v[224:227], v[192:195], 0
    ds_read_u16_d16_hi v88, v10 offset:16384
    ds_read_u16_d16_hi v90, v10 offset:17408
    ds_read_u16_d16_hi v92, v8 offset:16896
    ds_read_u16_d16_hi v94, v8 offset:17920
    ds_read_u16_d16_hi v89, v10 offset:18432
    v_mfma_f32_32x32x16_bf16 v[176:191], v[248:251], v[192:195], 0
    ds_read_u16_d16_hi v91, v10 offset:19456
    ds_read_u16_d16_hi v93, v8 offset:18944
    ds_read_u16_d16_hi v95, v8 offset:19968
    ds_read_u16_d16_hi v96, v10 offset:20480
    ds_read_u16_d16_hi v98, v10 offset:21504
    v_mfma_f32_32x32x16_bf16 v[160:175], v[228:231], v[196:199], v[160:175]
    ds_read_u16_d16_hi v100, v8 offset:20992
PADS5:
    s_cbranch_execz PADS6
    ds_read_u16_d16_hi v102, v8 offset:22016
    ds_read_u16_d16_hi v97, v10 offset:22528
    ds_read_u16_d16_hi v99, v10 offset:23552
    ds_read_u16_d16_hi v101, v8 offset:23040
    v_mfma_f32_32x32x16_bf16 v[176:191], v[252:255], v[196:199], v[176:191]
    ds_read_u16_d16_hi v103, v8 offset:24064
    ds_read_u16_d16_hi v104, v10 offset:32768
    ds_read_u16_d16_hi v106, v10 offset:33792
    ds_read_u16_d16_hi v108, v8 offset:33280
    ds_read_u16_d16_hi v110, v8 offset:34304
    v_mfma_f32_32x32x16_bf16 v[160:175], v[232:235], v[200:203], v[160:175]
    ds_read_u16_d16_hi v105, v10 offset:34816
    ds_read_u16_d16_hi v107, v10 offset:35840
    ds_read_u16_d16_hi v109, v8 offset:35328
    ds_read_u16_d16_hi v111, v8 offset:36352
    ds_read_u16_d16_hi v112, v10 offset:36864
PADS6:
    s_cbranch_execz PADS7
    v_mfma_f32_32x32x16_bf16 v[176:191], v[240:243], v[200:203], v[176:191]
    ds_read_u16_d16_hi v114, v10 offset:37888
    ds_read_u16_d16_hi v116, v8 offset:37376
    ds_read_u16_d16_hi v118, v8 offset:38400
    ds_read_u16_d16_hi v113, v10 offset:38912
    ds_read_u16_d16_hi v115, v10 offset:39936
    v_mfma_f32_32x32x16_bf16 v[160:175], v[236:239], v[204:207], v[160:175]
    ds_read_u16_d16_hi v117, v8 offset:39424
    ds_read_u16_d16_hi v119, v8 offset:40448
    ds_read_u16_d16_hi v120, v10 offset:49152
    ds_read_u16_d16_hi v122, v10 offset:50176
    ds_read_u16_d16_hi v124, v8 offset:49664
    v_mfma_f32_32x32x16_bf16 v[176:191], v[244:247], v[204:207], v[176:191]
    ds_read_u16_d16_hi v126, v8 offset:50688
    ds_read_u16_d16_hi v121, v10 offset:51200
PADS7:
    s_cbranch_execz PADS8
    ds_read_u16_d16_hi v123, v10 offset:52224
    ds_read_u16_d16_hi v125, v8 offset:51712
    ds_read_u16_d16_hi v127, v8 offset:52736
    ds_read_b128 v[224:227], v14 offset:8192
    ds_read_b128 v[228:231], v14 offset:9216
    ds_read_b128 v[232:235], v14 offset:10240
    ds_read_b128 v[236:239], v14 offset:11264
    ds_read_b128 v[240:243], v14 offset:12288
    ds_read_b128 v[244:247], v14 offset:13312
    ds_read_b128 v[248:251], v14 offset:14336
    ds_read_b128 v[252:255], v14 offset:15360
    s_cmp_lg_u32 s34, 1
    s_cbranch_scc1 NOYP
    s_setprio 1
NOYP:
    v_mov_b32 v192, v128
    v_mov_b32 v193, v144
    v_mov_b32 v194, v160
    v_mov_b32 v195, v176
    v_sub_f32 v4, v128, v176
    v_add_f32 v6, v160, v144
PADS8:
    s_cbranch_execz RETS
    v_add_f32 v128, v128, v176
    v_sub_f32 v160, v160, v144
    s_waitcnt lgkmcnt(15)
    v_mul_f32 v176, v4, v72
    v_mul_f32 v144, v4, v74
    v_fmac_f32 v176, v6, v74
    v_fma_f32 v144, -v6, v72, v144
    v_fma_f32 v4, v128, v76, v176
    v_fma_f32 v6, v128, v78, v144
    v_fma_f32 v128, v160, v78, v4
    v_fma_f32 v160, -v160, v76, v6
    v_fma_f32 v176, v176, 2.0, -v128
    v_fma_f32 v144, v144, -2.0, v160
    v_sub_f32 v5, v129, v177
    v_add_f32 v7, v161, v145
    v_add_f32 v129, v129, v177
    v_sub_f32 v161, v161, v145
    v_mul_f32 v177, v5, v73
    v_mul_f32 v145, v5, v75
    v_fmac_f32 v177, v7, v75
    v_fma_f32 v145, -v7, v73, v145
    v_fma_f32 v5, v129, v77, v177
PADS9:
    s_cbranch_execz PADS10
    v_fma_f32 v7, v129, v79, v145
    v_fma_f32 v129, v161, v79, v5
    v_fma_f32 v161, -v161, v77, v7
    v_fma_f32 v177, v177, 2.0, -v129
    v_fma_f32 v145, v145, -2.0, v161
    s_cmp_lg_u32 s2, 0
    s_cbranch_scc1 NOFIX
    s_mov_b32 exec_hi, 0
    v_mul_f32 v128, v192, v72
    v_mul_f32 v160, v192, v74
    v_mul_f32 v144, v193, v76
    v_mul_f32 v176, v193, v78
    v_fmac_f32 v128, v194, v74
    v_fma_f32 v160, -v194, v72, v160
    v_fmac_f32 v144, v195, v78
    v_fma_f32 v176, -v195, v76, v176
    s_mov_b32 exec_hi, -1
NOFIX:
    ds_read_u16_d16_hi v72, v10 offset:53248
    ds_read_u16_d16_hi v74, v10 offset:54272
    ds_read_u16_d16_hi v76, v8 offset:53760
    ds_read_u16_d16_hi v78, v8 offset:54784
PADS10:
    s_cbranch_execz PADS11
    ds_read_u16_d16_hi v73, v10 offset:55296
    ds_read_u16_d16_hi v75, v10 offset:56320
    ds_read_u16_d16_hi v77, v8 offset:55808
    ds_read_u16_d16_hi v79, v8 offset:56832
    v_cvt_pk_bf16_f32 v192, v128, v129
    v_cvt_pk_bf16_f32 v208, v160, v161
    v_cvt_pk_bf16_f32 v216, v176, v177
    v_cvt_pk_bf16_f32 v200, v144, v145
    s_cmp_lg_u32 s34, 1
    s_cbranch_scc1 RB13
    s_barrier
RB13:
    v_sub_f32 v4, v130, v178
    v_add_f32 v6, v162, v146
    v_add_f32 v130, v130, v178
    v_sub_f32 v162, v162, v146
    v_mul_f32 v178, v4, v80
    v_mul_f32 v146, v4, v82
    v_fmac_f32 v178, v6, v82
    v_fma_f32 v146, -v6, v80, v146
    v_fma_f32 v4, v130, v84, v178
PADS11:
    s_cbranch_execz PADS12
    v_fma_f32 v6, v130, v86, v146
    v_fma_f32 v130, v162, v86, v4
    v_fma_f32 v162, -v162, v84, v6
    v_fma_f32 v178, v178, 2.0, -v130
    v_fma_f32 v146, v146, -2.0, v162
    v_sub_f32 v5, v131, v179
    v_add_f32 v7, v163, v147
    v_add_f32 v131, v131, v179
    v_sub_f32 v163, v163, v147
    v_mul_f32 v179, v5, v81
    v_mul_f32 v147, v5, v83
    v_fmac_f32 v179, v7, v83
    v_fma_f32 v147, -v7, v81, v147
    v_fma_f32 v5, v131, v85, v179
    v_fma_f32 v7, v131, v87, v147
    v_fma_f32 v131, v163, v87, v5
    v_fma_f32 v163, -v163, v85, v7
    v_fma_f32 v179, v179, 2.0, -v131
    v_fma_f32 v147, v147, -2.0, v163
PADS12:
    s_cbranch_execz PADS13
    v_cvt_pk_bf16_f32 v193, v130, v131
    v_cvt_pk_bf16_f32 v209, v162, v163
    v_cvt_pk_bf16_f32 v217, v178, v179
    v_cvt_pk_bf16_f32 v201, v146, v147
    v_sub_f32 v4, v132, v180
    v_add_f32 v6, v164, v148
    v_add_f32 v132, v132, v180
    v_sub_f32 v164, v164, v148
    v_mul_f32 v180, v4, v88
    v_mul_f32 v148, v4, v90
    v_fmac_f32 v180, v6, v90
    v_fma_f32 v148, -v6, v88, v148
    v_fma_f32 v4, v132, v92, v180
    v_fma_f32 v6, v132, v94, v148
    v_fma_f32 v132, v164, v94, v4
    v_fma_f32 v164, -v164, v92, v6
    v_fma_f32 v180, v180, 2.0, -v132
    v_fma_f32 v148, v148, -2.0, v164
    v_sub_f32 v5, v133, v181
    v_add_f32 v7, v165, v149
PADS13:
    s_cbranch_execz PADS14
    v_add_f32 v133, v133, v181
    v_sub_f32 v165, v165, v149
    v_mul_f32 v181, v5, v89
    v_mul_f32 v149, v5, v91
    v_fmac_f32 v181, v7, v91
    v_fma_f32 v149, -v7, v89, v149
    v_fma_f32 v5, v133, v93, v181
    v_fma_f32 v7, v133, v95, v149
    v_fma_f32 v133, v165, v95, v5
    v_fma_f32 v165, -v165, v93, v7
    v_fma_f32 v181, v181, 2.0, -v133
    v_fma_f32 v149, v149, -2.0, v165
    v_cvt_pk_bf16_f32 v194, v132, v133
    v_cvt_pk_bf16_f32 v210, v164, v165
    v_cvt_pk_bf16_f32 v218, v180, v181
    v_cvt_pk_bf16_f32 v202, v148, v149
    v_sub_f32 v4, v134, v182
    v_add_f32 v6, v166, v150
    v_add_f32 v134, v134, v182
    v_sub_f32 v166, v166, v150
PADS14:
    s_cbranch_execz PADS15
    v_mul_f32 v182, v4, v96
    v_mul_f32 v150, v4, v98
    v_fmac_f32 v182, v6, v98
    v_fma_f32 v150, -v6, v96, v150
    v_fma_f32 v4, v134, v100, v182
    v_fma_f32 v6, v134, v102, v150
    v_fma_f32 v134, v166, v102, v4
    v_fma_f32 v166, -v166, v100, v6
    v_fma_f32 v182, v182, 2.0, -v134
    v_fma_f32 v150, v150, -2.0, v166
    v_sub_f32 v5, v135, v183
    v_add_f32 v7, v167, v151
    v_add_f32 v135, v135, v183
    v_sub_f32 v167, v167, v151
    v_mul_f32 v183, v5, v97
    v_mul_f32 v151, v5, v99
    v_fmac_f32 v183, v7, v99
    v_fma_f32 v151, -v7, v97, v151
    v_fma_f32 v5, v135, v101, v183
    v_fma_f32 v7, v135, v103, v151
    v_fma_f32 v135, v167, v103, v5
PADS15:
    s_cbranch_execz PADS16
    v_fma_f32 v167, -v167, v101, v7
    v_fma_f32 v183, v183, 2.0, -v135
    v_fma_f32 v151, v151, -2.0, v167
    v_cvt_pk_bf16_f32 v195, v134, v135
    v_cvt_pk_bf16_f32 v211, v166, v167
    v_cvt_pk_bf16_f32 v219, v182, v183
    v_cvt_pk_bf16_f32 v203, v150, v151
    v_sub_f32 v4, v136, v184
    v_add_f32 v6, v168, v152
    v_add_f32 v136, v136, v184
    v_sub_f32 v168, v168, v152
    v_mul_f32 v184, v4, v104
    v_mul_f32 v152, v4, v106
    v_fmac_f32 v184, v6, v106
    v_fma_f32 v152, -v6, v104, v152
    v_fma_f32 v4, v136, v108, v184
    v_fma_f32 v6, v136, v110, v152
    v_fma_f32 v136, v168, v110, v4
    v_fma_f32 v168, -v168, v108, v6
PADS16:
    s_cbranch_execz PADS17
    v_fma_f32 v184, v184, 2.0, -v136
    v_fma_f32 v152, v152, -2.0, v168
    v_sub_f32 v5, v137, v185
    v_add_f32 v7, v169, v153
    v_add_f32 v137, v137, v185
    v_sub_f32 v169, v169, v153
    v_mul_f32 v185, v5, v105
    v_mul_f32 v153, v5, v107
    v_fmac_f32 v185, v7, v107
    v_fma_f32 v153, -v7, v105, v153
    v_fma_f32 v5, v137, v109, v185
    v_fma_f32 v7, v137, v111, v153
    v_fma_f32 v137, v169, v111, v5
    v_fma_f32 v169, -v169, v109, v7
    v_fma_f32 v185, v185, 2.0, -v137
    v_fma_f32 v153, v153, -2.0, v169
    v_cvt_pk_bf16_f32 v196, v136, v137
    v_cvt_pk_bf16_f32 v212, v168, v169
    v_cvt_pk_bf16_f32 v220, v184, v185
PADS17:
    s_cbranch_execz PADS18
    v_cvt_pk_bf16_f32 v204, v152, v153
    s_cmp_lg_u32 s34, 1
    s_cbranch_scc1 RB14
    s_barrier
RB14:
    v_sub_f32 v4, v138, v186
    v_add_f32 v6, v170, v154
    v_add_f32 v138, v138, v186
    v_sub_f32 v170, v170, v154
    v_mul_f32 v186, v4, v112
    v_mul_f32 v154, v4, v114
    v_fmac_f32 v186, v6, v114
    v_fma_f32 v154, -v6, v112, v154
    v_fma_f32 v4, v138, v116, v186
    v_fma_f32 v6, v138, v118, v154
    v_fma_f32 v138, v170, v118, v4
    v_fma_f32 v170, -v170, v116, v6
    v_fma_f32 v186, v186, 2.0, -v138
    v_fma_f32 v154, v154, -2.0, v170
    v_sub_f32 v5, v139, v187
    v_add_f32 v7, v171, v155
    v_add_f32 v139, v139, v187
    v_sub_f32 v171, v171, v155
PADS18:
    s_cbranch_execz RETS
    v_mul_f32 v187, v5, v113
    v_mul_f32 v155, v5, v115
    v_fmac_f32 v187, v7, v115
    v_fma_f32 v155, -v7, v113, v155
    v_fma_f32 v5, v139, v117, v187
    v_fma_f32 v7, v139, v119, v155
    v_fma_f32 v139, v171, v119, v5
    v_fma_f32 v171, -v171, v117, v7
    v_fma_f32 v187, v187, 2.0, -v139
    v_fma_f32 v155, v155, -2.0, v171
    v_cvt_pk_bf16_f32 v197, v138, v139
    v_cvt_pk_bf16_f32 v213, v170, v171
    v_cvt_pk_bf16_f32 v221, v186, v187
    v_cvt_pk_bf16_f32 v205, v154, v155
    v_sub_f32 v4, v140, v188
    v_add_f32 v6, v172, v156
    v_add_f32 v140, v140, v188
    v_sub_f32 v172, v172, v156
    v_mul_f32 v188, v4, v120
    s_waitcnt lgkmcnt(15)
PADS19:
    s_cbranch_execz PADS20
    v_mul_f32 v156, v4, v122
    v_fmac_f32 v188, v6, v122
    v_fma_f32 v156, -v6, v120, v156
    v_fma_f32 v4, v140, v124, v188
    v_fma_f32 v6, v140, v126, v156
    v_fma_f32 v140, v172, v126, v4
    v_fma_f32 v172, -v172, v124, v6
    v_fma_f32 v188, v188, 2.0, -v140
    v_fma_f32 v156, v156, -2.0, v172
    v_sub_f32 v5, v141, v189
    v_add_f32 v7, v173, v157
    v_add_f32 v141, v141, v189
    v_sub_f32 v173, v173, v157
    v_mul_f32 v189, v5, v121
    v_mul_f32 v157, v5, v123
    v_fmac_f32 v189, v7, v123
    v_fma_f32 v157, -v7, v121, v157
    v_fma_f32 v5, v141, v125, v189
    v_fma_f32 v7, v141, v127, v157
    v_fma_f32 v141, v173, v127, v5
PADS20:
    s_cbranch_execz PADS21
    v_fma_f32 v173, -v173, v125, v7
    v_fma_f32 v189, v189, 2.0, -v141
    v_fma_f32 v157, v157, -2.0, v173
    v_cvt_pk_bf16_f32 v198, v140, v141
    v_cvt_pk_bf16_f32 v214, v172, v173
    v_cvt_pk_bf16_f32 v222, v188, v189
    v_cvt_pk_bf16_f32 v206, v156, v157
    v_sub_f32 v4, v142, v190
    v_add_f32 v6, v174, v158
    v_add_f32 v142, v142, v190
    v_sub_f32 v174, v174, v158
    s_waitcnt lgkmcnt(7)
    v_mul_f32 v190, v4, v72
    s_waitcnt lgkmcnt(6)
    v_mul_f32 v158, v4, v74
    v_fmac_f32 v190, v6, v74
    v_fma_f32 v158, -v6, v72, v158
    s_waitcnt lgkmcnt(5)
    v_fma_f32 v4, v142, v76, v190
    s_waitcnt lgkmcnt(4)
    v_fma_f32 v6, v142, v78, v158
PADS21:
    s_cbranch_execz PADS22
    v_fma_f32 v142, v174, v78, v4
    v_fma_f32 v174, -v174, v76, v6
    v_fma_f32 v190, v190, 2.0, -v142
    v_fma_f32 v158, v158, -2.0, v174
    v_sub_f32 v5, v143, v191
    v_add_f32 v7, v175, v159
    v_add_f32 v143, v143, v191
    v_sub_f32 v175, v175, v159
    s_waitcnt lgkmcnt(3)
    v_mul_f32 v191, v5, v73
    s_waitcnt lgkmcnt(2)
    v_mul_f32 v159, v5, v75
    v_fmac_f32 v191, v7, v75
    v_fma_f32 v159, -v7, v73, v159
    s_waitcnt lgkmcnt(1)
    v_fma_f32 v5, v143, v77, v191
    s_waitcnt lgkmcnt(0)
    v_fma_f32 v7, v143, v79, v159
    v_fma_f32 v143, v175, v79, v5
    v_fma_f32 v175, -v175, v77, v7
    v_fma_f32 v191, v191, 2.0, -v143
PADS22:
    s_cbranch_execz PADS23
    v_fma_f32 v159, v159, -2.0, v175
    v_cvt_pk_bf16_f32 v199, v142, v143
    v_cvt_pk_bf16_f32 v215, v174, v175
    v_cvt_pk_bf16_f32 v223, v190, v191
    v_cvt_pk_bf16_f32 v207, v158, v159
    v_mfma_f32_32x32x16_bf16 v[128:143], v[192:195], v[224:227], 0
    v_mfma_f32_32x32x16_bf16 v[128:143], v[196:199], v[228:231], v[128:143]
    v_mfma_f32_32x32x16_bf16 v[128:143], v[200:203], v[248:251], v[128:143]
    v_mfma_f32_32x32x16_bf16 v[128:143], v[204:207], v[252:255], v[128:143]
    v_mfma_f32_32x32x16_bf16 v[144:159], v[192:195], v[232:235], 0
    v_mfma_f32_32x32x16_bf16 v[144:159], v[196:199], v[236:239], v[144:159]
    s_cmp_lg_u32 s34, 0
    s_cbranch_scc1 RB15
    s_barrier
RB15:
    v_mfma_f32_32x32x16_bf16 v[144:159], v[200:203], v[240:243], v[144:159]
    s_nop 8
    v_cvt_pk_bf16_f32 v72, v128, v129
    v_cvt_pk_bf16_f32 v73, v130, v131
PADS23:
    s_cbranch_execz PADS24
    v_cvt_pk_bf16_f32 v74, v132, v133
    v_mfma_f32_32x32x16_bf16 v[144:159], v[204:207], v[244:247], v[144:159]
    v_cvt_pk_bf16_f32 v75, v134, v135
    ds_write_b128 v11, v[72:75] offset:0
    v_mfma_f32_32x32x16_bf16 v[160:175], v[208:211], v[224:227], 0
    v_cvt_pk_bf16_f32 v76, v136, v137
    v_cvt_pk_bf16_f32 v77, v138, v139
    v_cvt_pk_bf16_f32 v78, v140, v141
    v_mfma_f32_32x32x16_bf16 v[160:175], v[212:215], v[228:231], v[160:175]
    v_cvt_pk_bf16_f32 v79, v142, v143
    ds_write_b128 v11, v[76:79] offset:1024
    v_mfma_f32_32x32x16_bf16 v[160:175], v[216:219], v[248:251], v[160:175]
    s_nop 1
    v_cvt_pk_bf16_f32 v80, v144, v145
    v_cvt_pk_bf16_f32 v81, v146, v147
    v_cvt_pk_bf16_f32 v82, v148, v149
PADS24:
    s_cbranch_execz PADS25
    v_mfma_f32_32x32x16_bf16 v[160:175], v[220:223], v[252:255], v[160:175]
    v_cvt_pk_bf16_f32 v83, v150, v151
    ds_write_b128 v11, v[80:83] offset:8192
    v_mfma_f32_32x32x16_bf16 v[176:191], v[208:211], v[232:235], 0
    v_cvt_pk_bf16_f32 v84, v152, v153
    v_cvt_pk_bf16_f32 v85, v154, v155
    v_cvt_pk_bf16_f32 v86, v156, v157
    v_mfma_f32_32x32x16_bf16 v[176:191], v[212:215], v[236:239], v[176:191]
    v_cvt_pk_bf16_f32 v87, v158, v159
    ds_write_b128 v11, v[84:87] offset:9216
    v_mfma_f32_32x32x16_bf16 v[176:191], v[216:219], v[240:243], v[176:191]
    s_nop 1
    v_cvt_pk_bf16_f32 v88, v160, v161
    v_cvt_pk_bf16_f32 v89, v162, v163
    v_cvt_pk_bf16_f32 v90, v164, v165
    v_mfma_f32_32x32x16_bf16 v[176:191], v[220:223], v[244:247], v[176:191]
PADS25:
    s_cbranch_execz PADS26
    v_cvt_pk_bf16_f32 v91, v166, v167
    ds_write_b128 v11, v[88:91] offset:16384
    v_cvt_pk_bf16_f32 v92, v168, v169
    v_cvt_pk_bf16_f32 v93, v170, v171
    v_cvt_pk_bf16_f32 v94, v172, v173
    v_cvt_pk_bf16_f32 v95, v174, v175
    ds_write_b128 v11, v[92:95] offset:17408
    s_nop 4
    v_cvt_pk_bf16_f32 v96, v176, v177
    v_cvt_pk_bf16_f32 v97, v178, v179
    v_cvt_pk_bf16_f32 v98, v180, v181
    v_cvt_pk_bf16_f32 v99, v182, v183
    ds_write_b128 v11, v[96:99] offset:24576
    v_cvt_pk_bf16_f32 v100, v184, v185
    v_cvt_pk_bf16_f32 v101, v186, v187
    v_cvt_pk_bf16_f32 v102, v188, v189
PADS26:
    s_cbranch_execz PADS27
    v_cvt_pk_bf16_f32 v103, v190, v191
    ds_write_b128 v11, v[100:103] offset:25600
    s_waitcnt lgkmcnt(0)
    s_barrier
    ds_read_b128 v[192:195], v12 offset:0
    ds_read_b128 v[196:199], v12 offset:8192
    ds_read_b128 v[200:203], v12 offset:16384
    ds_read_b128 v[204:207], v12 offset:24576
    ds_read_b128 v[208:211], v12 offset:1024
    ds_read_b128 v[212:215], v12 offset:9216
    ds_read_b128 v[216:219], v12 offset:17408
    ds_read_b128 v[220:223], v12 offset:25600
    s_waitcnt lgkmcnt(7)
    v_mfma_f32_32x32x16_bf16 v[128:143], v[192:195], v[16:19], 0
    ds_read_b128 v[224:227], v12 offset:2048
    s_waitcnt lgkmcnt(7)
    v_mfma_f32_32x32x16_bf16 v[144:159], v[196:199], v[16:19], 0
PADS27:
    s_cbranch_execz PADS28
    ds_read_b128 v[228:231], v12 offset:10240
    s_waitcnt lgkmcnt(7)
    v_mfma_f32_32x32x16_bf16 v[160:175], v[200:203], v[20:23], 0
    ds_read_b128 v[232:235], v12 offset:18432
    s_waitcnt lgkmcnt(7)
    v_mfma_f32_32x32x16_bf16 v[176:191], v[204:207], v[20:23], 0
    ds_read_b128 v[236:239], v12 offset:26624
    s_waitcnt lgkmcnt(7)
    v_mfma_f32_32x32x16_bf16 v[128:143], v[208:211], v[24:27], v[128:143]
    ds_read_b128 v[192:195], v12 offset:3072
    s_waitcnt lgkmcnt(7)
    v_mfma_f32_32x32x16_bf16 v[144:159], v[212:215], v[24:27], v[144:159]
    ds_read_b128 v[196:199], v12 offset:11264
    s_waitcnt lgkmcnt(7)
    v_mfma_f32_32x32x16_bf16 v[160:175], v[216:219], v[28:31], v[160:175]
    ds_read_b128 v[200:203], v12 offset:19456
    s_waitcnt lgkmcnt(7)
    v_mfma_f32_32x32x16_bf16 v[176:191], v[220:223], v[28:31], v[176:191]
    ds_read_b128 v[204:207], v12 offset:27648
PADS28:
    s_cbranch_execz RETS
    s_waitcnt lgkmcnt(7)
    v_mfma_f32_32x32x16_bf16 v[128:143], v[224:227], v[32:35], v[128:143]
    ds_read_b128 v[208:211], v12 offset:4096
    s_waitcnt lgkmcnt(7)
    v_mfma_f32_32x32x16_bf16 v[144:159], v[228:231], v[32:35], v[144:159]
    ds_read_b128 v[212:215], v12 offset:12288
    s_waitcnt lgkmcnt(7)
    v_mfma_f32_32x32x16_bf16 v[160:175], v[232:235], v[36:39], v[160:175]
    ds_read_b128 v[216:219], v12 offset:20480
    s_waitcnt lgkmcnt(7)
    v_mfma_f32_32x32x16_bf16 v[176:191], v[236:239], v[36:39], v[176:191]
    ds_read_b128 v[220:223], v12 offset:28672
    s_waitcnt lgkmcnt(7)
    v_mfma_f32_32x32x16_bf16 v[128:143], v[192:195], v[40:43], v[128:143]
    ds_read_b128 v[224:227], v12 offset:5120
    s_waitcnt lgkmcnt(7)
    v_mfma_f32_32x32x16_bf16 v[144:159], v[196:199], v[40:43], v[144:159]
    ds_read_b128 v[228:231], v12 offset:13312
PADS29:
    s_cbranch_execz PADS30
    s_waitcnt lgkmcnt(7)
    v_mfma_f32_32x32x16_bf16 v[160:175], v[200:203], v[44:47], v[160:175]
    ds_read_b128 v[232:235], v12 offset:21504
    s_waitcnt lgkmcnt(7)
    v_mfma_f32_32x32x16_bf16 v[176:191], v[204:207], v[44:47], v[176:191]
    ds_read_b128 v[236:239], v12 offset:29696
    s_waitcnt lgkmcnt(7)
    v_mfma_f32_32x32x16_bf16 v[128:143], v[208:211], v[48:51], v[128:143]
    ds_read_b128 v[192:195], v12 offset:6144
    s_waitcnt lgkmcnt(7)
    v_mfma_f32_32x32x16_bf16 v[144:159], v[212:215], v[48:51], v[144:159]
    ds_read_b128 v[196:199], v12 offset:14336
    s_waitcnt lgkmcnt(7)
    v_mfma_f32_32x32x16_bf16 v[160:175], v[216:219], v[52:55], v[160:175]
    ds_read_b128 v[200:203], v12 offset:22528
    s_waitcnt lgkmcnt(7)
    v_mfma_f32_32x32x16_bf16 v[176:191], v[220:223], v[52:55], v[176:191]
    ds_read_b128 v[204:207], v12 offset:30720
    s_waitcnt lgkmcnt(7)
PADS30:
    s_cbranch_execz PADS31
    v_mfma_f32_32x32x16_bf16 v[128:143], v[224:227], v[56:59], v[128:143]
    s_waitcnt lgkmcnt(6)
    v_mfma_f32_32x32x16_bf16 v[144:159], v[228:231], v[56:59], v[144:159]
    s_waitcnt lgkmcnt(5)
    v_mfma_f32_32x32x16_bf16 v[160:175], v[232:235], v[60:63], v[160:175]
    s_waitcnt lgkmcnt(4)
    v_mfma_f32_32x32x16_bf16 v[176:191], v[236:239], v[60:63], v[176:191]
    s_waitcnt lgkmcnt(3)
    v_mfma_f32_32x32x16_bf16 v[128:143], v[192:195], v[64:67], v[128:143]
    s_waitcnt lgkmcnt(2)
    v_mfma_f32_32x32x16_bf16 v[144:159], v[196:199], v[64:67], v[144:159]
    s_waitcnt lgkmcnt(1)
    v_mfma_f32_32x32x16_bf16 v[160:175], v[200:203], v[68:71], v[160:175]
    s_waitcnt lgkmcnt(0)
    v_mfma_f32_32x32x16_bf16 v[176:191], v[204:207], v[68:71], v[176:191]
    s_nop 9
    v_sub_f32 v4, v128, v160
    s_nop 0
    v_sub_f32 v6, v144, v176
    v_add_f32 v128, v128, v160
    v_add_f32 v144, v144, v176
    v_cvt_pk_bf16_f32 v160, v4, v6
PADS31:
    s_cbranch_execz PADS32
    v_cvt_pk_bf16_f32 v176, v128, v144
    s_add_u32 s49, s53, 0
    buffer_store_dword v160, v13, s[16:19], s49 offen sc1
    buffer_store_dword v176, v13, s[16:19], s49 offen offset:512 sc1
    v_sub_f32 v5, v129, v161
    v_sub_f32 v7, v145, v177
    v_add_f32 v129, v129, v161
    v_add_f32 v145, v145, v177
    v_cvt_pk_bf16_f32 v161, v5, v7
    v_cvt_pk_bf16_f32 v177, v129, v145
    s_add_u32 s49, s53, 65536
    buffer_store_dword v161, v13, s[16:19], s49 offen sc1
    buffer_store_dword v177, v13, s[16:19], s49 offen offset:512 sc1
    s_cmp_lg_u32 s34, 0
    s_cbranch_scc1 RB16
    s_barrier
RB16:
    v_sub_f32 v4, v130, v162
    v_sub_f32 v6, v146, v178
    v_add_f32 v130, v130, v162
    v_add_f32 v146, v146, v178
    v_cvt_pk_bf16_f32 v162, v4, v6
    v_cvt_pk_bf16_f32 v178, v130, v146
PADS32:
    s_cbranch_execz PADS33
    s_add_u32 s49, s53, 131072
    buffer_store_dword v162, v13, s[16:19], s49 offen sc1
    buffer_store_dword v178, v13, s[16:19], s49 offen offset:512 sc1
    v_sub_f32 v5, v131, v163
    v_sub_f32 v7, v147, v179
    v_add_f32 v131, v131, v163
    v_add_f32 v147, v147, v179
    v_cvt_pk_bf16_f32 v163, v5, v7
    v_cvt_pk_bf16_f32 v179, v131, v147
    s_add_u32 s49, s53, 196608
    buffer_store_dword v163, v13, s[16:19], s49 offen sc1
    buffer_store_dword v179, v13, s[16:19], s49 offen offset:512 sc1
    v_sub_f32 v4, v132, v164
    v_sub_f32 v6, v148, v180
    v_add_f32 v132, v132, v164
    v_add_f32 v148, v148, v180
    v_cvt_pk_bf16_f32 v164, v4, v6
    v_cvt_pk_bf16_f32 v180, v132, v148
    s_add_u32 s49, s53, 524288
PADS33:
    s_cbranch_execz PADS34
    buffer_store_dword v164, v13, s[16:19], s49 offen sc1
    buffer_store_dword v180, v13, s[16:19], s49 offen offset:512 sc1
    v_sub_f32 v5, v133, v165
    v_sub_f32 v7, v149, v181
    v_add_f32 v133, v133, v165
    v_add_f32 v149, v149, v181
    v_cvt_pk_bf16_f32 v165, v5, v7
    v_cvt_pk_bf16_f32 v181, v133, v149
    s_add_u32 s49, s53, 589824
    buffer_store_dword v165, v13, s[16:19], s49 offen sc1
    buffer_store_dword v181, v13, s[16:19], s49 offen offset:512 sc1
    v_sub_f32 v4, v134, v166
    v_sub_f32 v6, v150, v182
    v_add_f32 v134, v134, v166
    v_add_f32 v150, v150, v182
    v_cvt_pk_bf16_f32 v166, v4, v6
    v_cvt_pk_bf16_f32 v182, v134, v150
    s_add_u32 s49, s53, 655360
    buffer_store_dword v166, v13, s[16:19], s49 offen sc1
    buffer_store_dword v182, v13, s[16:19], s49 offen offset:512 sc1
PADS34:
    s_cbranch_execz PADS35
    v_sub_f32 v5, v135, v167
    v_sub_f32 v7, v151, v183
    v_add_f32 v135, v135, v167
    v_add_f32 v151, v151, v183
    v_cvt_pk_bf16_f32 v167, v5, v7
    v_cvt_pk_bf16_f32 v183, v135, v151
    s_add_u32 s49, s53, 720896
    buffer_store_dword v167, v13, s[16:19], s49 offen sc1
    buffer_store_dword v183, v13, s[16:19], s49 offen offset:512 sc1
    v_sub_f32 v4, v136, v168
    v_sub_f32 v6, v152, v184
    v_add_f32 v136, v136, v168
    v_add_f32 v152, v152, v184
    v_cvt_pk_bf16_f32 v168, v4, v6
    v_cvt_pk_bf16_f32 v184, v136, v152
    s_add_u32 s49, s53, 1048576
    buffer_store_dword v168, v13, s[16:19], s49 offen sc1
    buffer_store_dword v184, v13, s[16:19], s49 offen offset:512 sc1
    v_sub_f32 v5, v137, v169
    v_sub_f32 v7, v153, v185
PADS35:
    s_cbranch_execz PADS36
    v_add_f32 v137, v137, v169
    v_add_f32 v153, v153, v185
    v_cvt_pk_bf16_f32 v169, v5, v7
    v_cvt_pk_bf16_f32 v185, v137, v153
    s_add_u32 s49, s53, 1114112
    buffer_store_dword v169, v13, s[16:19], s49 offen sc1
    buffer_store_dword v185, v13, s[16:19], s49 offen offset:512 sc1
    v_sub_f32 v4, v138, v170
    v_sub_f32 v6, v154, v186
    v_add_f32 v138, v138, v170
    v_add_f32 v154, v154, v186
    v_cvt_pk_bf16_f32 v170, v4, v6
    v_cvt_pk_bf16_f32 v186, v138, v154
    s_add_u32 s49, s53, 1179648
    buffer_store_dword v170, v13, s[16:19], s49 offen sc1
    buffer_store_dword v186, v13, s[16:19], s49 offen offset:512 sc1
    v_sub_f32 v5, v139, v171
    v_sub_f32 v7, v155, v187
    v_add_f32 v139, v139, v171
    v_add_f32 v155, v155, v187
    v_cvt_pk_bf16_f32 v171, v5, v7
PADS36:
    s_cbranch_execz PADS37
    v_cvt_pk_bf16_f32 v187, v139, v155
    s_add_u32 s49, s53, 1245184
    buffer_store_dword v171, v13, s[16:19], s49 offen sc1
    buffer_store_dword v187, v13, s[16:19], s49 offen offset:512 sc1
    v_sub_f32 v4, v140, v172
    v_sub_f32 v6, v156, v188
    v_add_f32 v140, v140, v172
    v_add_f32 v156, v156, v188
    v_cvt_pk_bf16_f32 v172, v4, v6
    v_cvt_pk_bf16_f32 v188, v140, v156
    s_add_u32 s49, s53, 1572864
    buffer_store_dword v172, v13, s[16:19], s49 offen sc1
    buffer_store_dword v188, v13, s[16:19], s49 offen offset:512 sc1
    v_sub_f32 v5, v141, v173
    v_sub_f32 v7, v157, v189
    v_add_f32 v141, v141, v173
    v_add_f32 v157, v157, v189
    v_cvt_pk_bf16_f32 v173, v5, v7
    v_cvt_pk_bf16_f32 v189, v141, v157
PADS37:
    s_cbranch_execz PADS38
    s_add_u32 s49, s53, 1638400
    buffer_store_dword v173, v13, s[16:19], s49 offen sc1
    buffer_store_dword v189, v13, s[16:19], s49 offen offset:512 sc1
    v_sub_f32 v4, v142, v174
    v_sub_f32 v6, v158, v190
    v_add_f32 v142, v142, v174
    v_add_f32 v158, v158, v190
    v_cvt_pk_bf16_f32 v174, v4, v6
    v_cvt_pk_bf16_f32 v190, v142, v158
    s_add_u32 s49, s53, 1703936
    buffer_store_dword v174, v13, s[16:19], s49 offen sc1
    buffer_store_dword v190, v13, s[16:19], s49 offen offset:512 sc1
    v_sub_f32 v5, v143, v175
    v_sub_f32 v7, v159, v191
    v_add_f32 v143, v143, v175
    v_add_f32 v159, v159, v191
    v_cvt_pk_bf16_f32 v175, v5, v7
    v_cvt_pk_bf16_f32 v191, v143, v159
    s_add_u32 s49, s53, 1769472
    buffer_store_dword v175, v13, s[16:19], s49 offen sc1
PADS38:
    s_cbranch_execz RETS
    buffer_store_dword v191, v13, s[16:19], s49 offen offset:512 sc1
    v_lshlrev_b32 v4, 10, v1
    s_waitcnt vmcnt(0)
    s_barrier
    s_cmp_lg_u32 s3, 0
    s_cbranch_scc1 W0_17
    s_mov_b64 exec, 0xff
    buffer_store_dword v3, v4, s[16:19], s37 offen offset:900 sc1
    s_mov_b64 exec, -1
W0_17:
KEND:
    s_endpgm
.section .rodata,"a"
.p2align 6
.amdhsa_kernel recurrent_scan__spectral_gfnet__swiglu_ffn__prompt_kernel
  .amdhsa_next_free_vgpr 256
  .amdhsa_next_free_sgpr 102
  .amdhsa_accum_offset 256
  .amdhsa_group_segment_fixed_size 0
  .amdhsa_kernarg_size 80
  .amdhsa_user_sgpr_count 2
  .amdhsa_user_sgpr_kernarg_segment_ptr 1
  .amdhsa_system_sgpr_workgroup_id_x 1
.end_amdhsa_kernel
```
